```python
import torch

def _softmax(x, axis=-1):
    return torch.softmax(x, dim=axis)
def _gelu(x):
    return torch.nn.functional.gelu(x, approximate="tanh")
def _silu(x):
    return torch.nn.functional.silu(x)
def _sigmoid(x):
    return torch.sigmoid(x)
def _layernorm(x, axis=-1, eps=1e-5):
    m = x.mean(dim=axis, keepdim=True)
    v = x.var(dim=axis, keepdim=True, unbiased=False)
    return (x - m) / torch.sqrt(v + eps)
def _scatter_add(tgt, idx, src, axis=0):
    return tgt.clone().index_add_(axis, idx, src)
def _segment_sum(src, seg, n):
    out = torch.zeros((n,) + src.shape[1:], dtype=src.dtype)
    return out.index_add_(0, seg, src)
def _pad(x, pw):
    flat = tuple(v for pair in reversed(pw) for v in pair)
    return torch.nn.functional.pad(x, flat)

kernel_name = 'parallel_sum__linear_kernel_hedgehog__glu_gated_bilinear__prompt'

def setup_inputs():

    _w = (lambda a: (lambda t: t.to(torch.bfloat16) if t.is_floating_point() else t)(torch.as_tensor(a)))
    def _A_setup():
        B, S, D, H = 1, 2048, 640, 32
        Dh = D // H
        return {
            "x": _w((lambda *s: torch.randn(*s, dtype=torch.bfloat16) * 0.05)(B, S, D)),
            "wqkv": _w((lambda *s: torch.randn(*s, dtype=torch.bfloat16) * 0.2)(D, 3 * D)),
            "w_phi": _w((lambda *s: torch.randn(*s, dtype=torch.bfloat16) * 0.2)(H, Dh, Dh) * (Dh ** -0.5)),
            "wo": _w((lambda *s: torch.randn(*s, dtype=torch.bfloat16) * 0.05)(D, D)),
        }
    _A_in = _A_setup()

    def _B_setup():
        B, S, D, F = 1, 2048, 640, 1536
        return {
            "x": _w((lambda *s: torch.randn(*s, dtype=torch.bfloat16) * 0.05)(B, S, D)),
            "w_gate": _w((lambda *s: torch.randn(*s, dtype=torch.bfloat16) * 0.4)(D, F) * (D ** -0.5)),
            "w_up": _w((lambda *s: torch.randn(*s, dtype=torch.bfloat16) * 0.4)(D, F) * (D ** -0.5)),
            "w_down": _w((lambda *s: torch.randn(*s, dtype=torch.bfloat16) * 0.4)(F, D) * (F ** -0.5)),
        }
    _B_in = _B_setup()

    return {
        "A_x": _A_in["x"],
        "A_wqkv": _A_in["wqkv"],
        "A_w_phi": _A_in["w_phi"],
        "A_wo": _A_in["wo"],
        "B_x": _B_in["x"],
        "B_w_gate": _B_in["w_gate"],
        "B_w_up": _B_in["w_up"],
        "B_w_down": _B_in["w_down"],
    }

def reference(A_x, A_wqkv, A_w_phi, A_wo, B_x, B_w_gate, B_w_up, B_w_down):
    def _A_ref(x, wqkv, w_phi, wo):
        B, S, D = x.shape
        H = 32; Dh = D // H
        qkv = (lambda x, *d: x.permute(*d))((x @ wqkv).reshape(B, S, 3, H, Dh), 2, 0, 3, 1, 4)
        q, k, v = qkv[0], qkv[1], qkv[2]
        pq = torch.einsum("bhsd,hdf->bhsf", q, w_phi)
        pk = torch.einsum("bhsd,hdf->bhsf", k, w_phi)
        phi_q = torch.concatenate([_softmax(pq, axis=-1), _softmax(-pq, axis=-1)], axis=-1)
        phi_k = torch.concatenate([_softmax(pk, axis=-1), _softmax(-pk, axis=-1)], axis=-1)
        kv = torch.einsum("bhsf,bhsd->bhfd", phi_k, v)
        z  = torch.einsum("bhsf->bhf", phi_k)
        num = torch.einsum("bhqf,bhfd->bhqd", phi_q, kv)
        den = torch.einsum("bhqf,bhf->bhq", phi_q, z)[..., None] + 1e-6
        o = num / den
        return (lambda x, *d: x.permute(*d))(o, 0, 2, 1, 3).reshape(B, S, D) @ wo

    def _B_ref(x, w_gate, w_up, w_down):
        g = torch.einsum("bsd,df->bsf", x, w_gate)
        u = torch.einsum("bsd,df->bsf", x, w_up)
        h = g * u
        return torch.einsum("bsf,fd->bsd", h, w_down)

    x = A_x
    xn = _layernorm(x, axis=-1)
    return x + _A_ref(xn, A_wqkv, A_w_phi, A_wo) + _B_ref(xn, B_w_gate, B_w_up, B_w_down)
```

```asm
; @launch kernel=k1_kernel grid=(256,1,1) block=(512,1,1) lds=163840
; @launch kernel=k3_kernel grid=(256,1,1) block=(512,1,1) lds=163840
.amdgcn_target "amdgcn-amd-amdhsa--gfx950"
.set ROTMUL, 5
.set ROTRB, 1
.text
.globl k1_kernel
.p2align 8
.type k1_kernel,@function
k1_kernel:
s_cmp_ge_u32 s2, 256
s_cbranch_scc0 L_k1_go
s_endpgm
L_k1_go:
s_load_dwordx4 s[4:7], s[0:1], 0
s_load_dwordx4 s[24:27], s[0:1], 16
s_load_dwordx4 s[28:31], s[0:1], 40
s_load_dwordx2 s[32:33], s[0:1], 56
s_load_dwordx2 s[34:35], s[0:1], 80
v_and_b32 v1, 63, v0
v_lshrrev_b32 v17, 6, v0
s_and_b32 s45, s2, 7
v_readfirstlane_b32 s36, v17
s_lshr_b32 s49, s2, 3
s_lshr_b32 s40, s49, 4
s_and_b32 s41, s49, 3
s_bfe_u32 s53, s49, 0x20002
s_and_b32 s37, s45, 3
s_lshl_b32 s37, s37, 2
s_add_u32 s37, s37, s41
s_lshr_b32 s38, s45, 2
s_lshl_b32 s38, s38, 2
s_add_u32 s38, s38, s53
s_lshr_b32 s57, s49, 2
s_mul_i32 s57, s57, ROTMUL
s_lshr_b32 s39, s57, 2
s_mov_b32 s50, 0xffff0000
s_mov_b32 s51, 0x3f803f80
s_lshr_b32 s54, s36, 2
s_and_b32 s55, s36, 3
v_lshrrev_b32 v17, 3, v1
s_lshl_b32 s45, s36, 4
v_add_u32 v17, s45, v17
v_mul_u32_u24 v24, 1280, v17
v_and_b32 v25, 7, v1
v_lshl_add_u32 v38, v25, 4, v24
v_add_u32 v39, 10240, v38
v_bfe_u32 v24, v17, 1, 3
v_xor_b32 v24, v24, v25
v_lshlrev_b32 v24, 4, v24
v_lshl_add_u32 v14, v17, 7, v24
v_xor_b32 v15, 64, v14
v_add_u32 v15, 1024, v15
s_waitcnt lgkmcnt(0)
s_mov_b32 s8, s4
s_and_b32 s9, s5, 0xffff
s_mov_b32 s10, 2621440
s_mov_b32 s11, 0x20000
s_cmp_eq_u32 s40, 1
s_cbranch_scc1 L_k1_A
s_mul_i32 s53, s37, 163840
s_lshl_b32 s57, s39, 7
s_add_u32 s52, s53, s57
buffer_load_dwordx4 v[80:83], v38, s[8:11], s52 offen
buffer_load_dwordx4 v[84:87], v39, s[8:11], s52 offen
s_add_u32 s57, s57, 128
s_cmp_eq_u32 s57, 1280
s_cselect_b32 s57, 0, s57
s_add_u32 s52, s53, s57
buffer_load_dwordx4 v[88:91], v38, s[8:11], s52 offen
buffer_load_dwordx4 v[92:95], v39, s[8:11], s52 offen
s_add_u32 s57, s57, 128
s_cmp_eq_u32 s57, 1280
s_cselect_b32 s57, 0, s57
v_mov_b32 v40, 0
v_mov_b32 v41, 0
v_mov_b32 v42, 0
v_mov_b32 v43, 0
v_mov_b32 v44, 0
v_mov_b32 v45, 0
v_mov_b32 v46, 0
v_mov_b32 v47, 0
s_waitcnt vmcnt(0)
s_add_u32 s52, s53, s57
buffer_load_dwordx4 v[96:99], v38, s[8:11], s52 offen
buffer_load_dwordx4 v[100:103], v39, s[8:11], s52 offen
s_add_u32 s57, s57, 128
s_cmp_eq_u32 s57, 1280
s_cselect_b32 s57, 0, s57
s_add_u32 s52, s53, s57
buffer_load_dwordx4 v[104:107], v38, s[8:11], s52 offen
buffer_load_dwordx4 v[108:111], v39, s[8:11], s52 offen
s_add_u32 s57, s57, 128
s_cmp_eq_u32 s57, 1280
s_cselect_b32 s57, 0, s57
s_add_u32 s52, s53, s57
buffer_load_dwordx4 v[112:115], v38, s[8:11], s52 offen
buffer_load_dwordx4 v[116:119], v39, s[8:11], s52 offen
s_add_u32 s57, s57, 128
s_cmp_eq_u32 s57, 1280
s_cselect_b32 s57, 0, s57
s_add_u32 s52, s53, s57
buffer_load_dwordx4 v[120:123], v38, s[8:11], s52 offen
buffer_load_dwordx4 v[124:127], v39, s[8:11], s52 offen
s_add_u32 s57, s57, 128
s_cmp_eq_u32 s57, 1280
s_cselect_b32 s57, 0, s57
s_add_u32 s52, s53, s57
buffer_load_dwordx4 v[128:131], v38, s[8:11], s52 offen
buffer_load_dwordx4 v[132:135], v39, s[8:11], s52 offen
s_add_u32 s57, s57, 128
s_cmp_eq_u32 s57, 1280
s_cselect_b32 s57, 0, s57
s_add_u32 s52, s53, s57
buffer_load_dwordx4 v[136:139], v38, s[8:11], s52 offen
buffer_load_dwordx4 v[140:143], v39, s[8:11], s52 offen
s_add_u32 s57, s57, 128
s_cmp_eq_u32 s57, 1280
s_cselect_b32 s57, 0, s57
s_add_u32 s52, s53, s57
buffer_load_dwordx4 v[144:147], v38, s[8:11], s52 offen
buffer_load_dwordx4 v[148:151], v39, s[8:11], s52 offen
s_add_u32 s57, s57, 128
s_cmp_eq_u32 s57, 1280
s_cselect_b32 s57, 0, s57
s_add_u32 s52, s53, s57
buffer_load_dwordx4 v[152:155], v38, s[8:11], s52 offen
buffer_load_dwordx4 v[156:159], v39, s[8:11], s52 offen
s_add_u32 s57, s57, 128
s_cmp_eq_u32 s57, 1280
s_cselect_b32 s57, 0, s57
s_cmp_lt_u32 s36, 4
s_cselect_b32 s45, s28, s30
s_cselect_b32 s49, s29, s31
s_mov_b32 s12, s45
s_and_b32 s13, s49, 0xffff
s_mov_b32 s14, 1966080
s_mov_b32 s15, 0x20000
s_mul_i32 s64, s39, 196608
s_add_u32 s65, s64, 98304
s_cmp_eq_u32 s65, 1966080
s_cselect_b32 s65, 0, s65
s_add_u32 s66, s65, 98304
s_cmp_eq_u32 s66, 1966080
s_cselect_b32 s66, 0, s66
s_add_u32 s67, s66, 98304
s_cmp_eq_u32 s67, 1966080
s_cselect_b32 s67, 0, s67
s_add_u32 s68, s67, 98304
s_cmp_eq_u32 s68, 1966080
s_cselect_b32 s68, 0, s68
s_mov_b32 s16, s34
s_and_b32 s17, s35, 0xffff
s_mov_b32 s18, 33554432
s_mov_b32 s19, 0x20000
v_and_b32 v17, 31, v1
v_lshrrev_b32 v24, 5, v1
v_bfe_u32 v25, v17, 1, 3
v_xor_b32 v25, v25, v24
v_lshlrev_b32 v25, 4, v25
s_lshl_b32 s45, s54, 13
v_lshl_add_u32 v25, v17, 7, v25
v_add_u32 v10, s45, v25
v_xor_b32 v11, 32, v10
v_xor_b32 v12, 64, v10
v_xor_b32 v13, 96, v10
v_lshrrev_b32 v29, 4, v1
v_bfe_u32 v26, v1, 2, 2
v_and_b32 v27, 3, v1
s_mul_i32 s45, s55, 12
s_mul_i32 s49, s38, 384
v_add_u32 v28, s45, v29
v_mul_u32_u24 v24, 43, v28
v_lshrrev_b32 v24, 8, v24
v_mul_u32_u24 v25, 6, v24
v_sub_u32 v25, v28, v25
v_lshl_add_u32 v24, v24, 2, v26
v_mul_u32_u24 v24, 3072, v24
v_lshl_add_u32 v24, v25, 6, v24
v_lshl_add_u32 v24, v27, 4, v24
v_add_u32 v2, s49, v24
v_add_u32 v28, s45, v29
v_add_u32 v28, 4, v28
v_mul_u32_u24 v24, 43, v28
v_lshrrev_b32 v24, 8, v24
v_mul_u32_u24 v25, 6, v24
v_sub_u32 v25, v28, v25
v_lshl_add_u32 v24, v24, 2, v26
v_mul_u32_u24 v24, 3072, v24
v_lshl_add_u32 v24, v25, 6, v24
v_lshl_add_u32 v24, v27, 4, v24
v_add_u32 v3, s49, v24
v_add_u32 v28, s45, v29
v_add_u32 v28, 8, v28
v_mul_u32_u24 v24, 43, v28
v_lshrrev_b32 v24, 8, v24
v_mul_u32_u24 v25, 6, v24
v_sub_u32 v25, v28, v25
v_lshl_add_u32 v24, v24, 2, v26
v_mul_u32_u24 v24, 3072, v24
v_lshl_add_u32 v24, v25, 6, v24
v_lshl_add_u32 v24, v27, 4, v24
v_add_u32 v4, s49, v24
s_mul_i32 s45, s54, 12320
s_mul_i32 s49, s55, 3072
s_add_u32 s44, s45, s49
s_add_u32 s44, s44, 32768
v_bfe_u32 v25, v1, 4, 1
v_mul_u32_u24 v25, 12320, v25
v_lshrrev_b32 v24, 5, v1
v_mul_u32_u24 v24, 3072, v24
v_add_u32 v25, v25, v24
v_bfe_u32 v24, v1, 2, 2
v_lshl_add_u32 v25, v24, 6, v25
v_and_b32 v24, 3, v1
v_lshl_add_u32 v25, v24, 3, v25
s_lshr_b32 s45, s55, 1
s_lshl_b32 s45, s45, 8
s_and_b32 s49, s55, 1
s_lshl_b32 s49, s49, 5
s_add_u32 s45, s45, s49
s_add_u32 s45, s45, 32768
v_add_u32 v6, s45, v25
v_add_u32 v7, 49664, v6
v_add_u32 v8, 99328, v6
v_dot2_f32_bf16 v40, v80, s51, v40
v_dot2_f32_bf16 v42, v80, v80, v42
v_dot2_f32_bf16 v41, v81, s51, v41
v_dot2_f32_bf16 v43, v81, v81, v43
v_dot2_f32_bf16 v40, v82, s51, v40
v_dot2_f32_bf16 v42, v82, v82, v42
v_dot2_f32_bf16 v41, v83, s51, v41
v_dot2_f32_bf16 v43, v83, v83, v43
v_dot2_f32_bf16 v44, v84, s51, v44
v_dot2_f32_bf16 v46, v84, v84, v46
v_dot2_f32_bf16 v45, v85, s51, v45
v_dot2_f32_bf16 v47, v85, v85, v47
v_dot2_f32_bf16 v44, v86, s51, v44
v_dot2_f32_bf16 v46, v86, v86, v46
v_dot2_f32_bf16 v45, v87, s51, v45
v_dot2_f32_bf16 v47, v87, v87, v47
v_dot2_f32_bf16 v40, v88, s51, v40
v_dot2_f32_bf16 v42, v88, v88, v42
v_dot2_f32_bf16 v41, v89, s51, v41
v_dot2_f32_bf16 v43, v89, v89, v43
v_dot2_f32_bf16 v40, v90, s51, v40
v_dot2_f32_bf16 v42, v90, v90, v42
v_dot2_f32_bf16 v41, v91, s51, v41
v_dot2_f32_bf16 v43, v91, v91, v43
v_dot2_f32_bf16 v44, v92, s51, v44
v_dot2_f32_bf16 v46, v92, v92, v46
v_dot2_f32_bf16 v45, v93, s51, v45
v_dot2_f32_bf16 v47, v93, v93, v47
v_dot2_f32_bf16 v44, v94, s51, v44
v_dot2_f32_bf16 v46, v94, v94, v46
v_dot2_f32_bf16 v45, v95, s51, v45
v_dot2_f32_bf16 v47, v95, v95, v47
s_add_u32 m0, s44, 0
s_nop 0
buffer_load_dwordx4 v2, s[12:15], s64 offen lds
s_add_u32 m0, s44, 1024
s_nop 0
buffer_load_dwordx4 v3, s[12:15], s64 offen lds
s_add_u32 m0, s44, 2048
s_nop 0
buffer_load_dwordx4 v4, s[12:15], s64 offen lds
s_waitcnt vmcnt(17)
v_dot2_f32_bf16 v40, v96, s51, v40
v_dot2_f32_bf16 v42, v96, v96, v42
v_dot2_f32_bf16 v41, v97, s51, v41
v_dot2_f32_bf16 v43, v97, v97, v43
v_dot2_f32_bf16 v40, v98, s51, v40
v_dot2_f32_bf16 v42, v98, v98, v42
v_dot2_f32_bf16 v41, v99, s51, v41
v_dot2_f32_bf16 v43, v99, v99, v43
v_dot2_f32_bf16 v44, v100, s51, v44
v_dot2_f32_bf16 v46, v100, v100, v46
v_dot2_f32_bf16 v45, v101, s51, v45
v_dot2_f32_bf16 v47, v101, v101, v47
v_dot2_f32_bf16 v44, v102, s51, v44
v_dot2_f32_bf16 v46, v102, v102, v46
v_dot2_f32_bf16 v45, v103, s51, v45
v_dot2_f32_bf16 v47, v103, v103, v47
s_waitcnt vmcnt(15)
v_dot2_f32_bf16 v40, v104, s51, v40
v_dot2_f32_bf16 v42, v104, v104, v42
v_dot2_f32_bf16 v41, v105, s51, v41
v_dot2_f32_bf16 v43, v105, v105, v43
v_dot2_f32_bf16 v40, v106, s51, v40
v_dot2_f32_bf16 v42, v106, v106, v42
v_dot2_f32_bf16 v41, v107, s51, v41
v_dot2_f32_bf16 v43, v107, v107, v43
v_dot2_f32_bf16 v44, v108, s51, v44
v_dot2_f32_bf16 v46, v108, v108, v46
v_dot2_f32_bf16 v45, v109, s51, v45
v_dot2_f32_bf16 v47, v109, v109, v47
v_dot2_f32_bf16 v44, v110, s51, v44
v_dot2_f32_bf16 v46, v110, v110, v46
v_dot2_f32_bf16 v45, v111, s51, v45
v_dot2_f32_bf16 v47, v111, v111, v47
s_waitcnt vmcnt(13)
v_dot2_f32_bf16 v40, v112, s51, v40
v_dot2_f32_bf16 v42, v112, v112, v42
v_dot2_f32_bf16 v41, v113, s51, v41
v_dot2_f32_bf16 v43, v113, v113, v43
v_dot2_f32_bf16 v40, v114, s51, v40
v_dot2_f32_bf16 v42, v114, v114, v42
v_dot2_f32_bf16 v41, v115, s51, v41
v_dot2_f32_bf16 v43, v115, v115, v43
v_dot2_f32_bf16 v44, v116, s51, v44
v_dot2_f32_bf16 v46, v116, v116, v46
v_dot2_f32_bf16 v45, v117, s51, v45
v_dot2_f32_bf16 v47, v117, v117, v47
v_dot2_f32_bf16 v44, v118, s51, v44
v_dot2_f32_bf16 v46, v118, v118, v46
v_dot2_f32_bf16 v45, v119, s51, v45
v_dot2_f32_bf16 v47, v119, v119, v47
s_waitcnt vmcnt(11)
v_dot2_f32_bf16 v40, v120, s51, v40
v_dot2_f32_bf16 v42, v120, v120, v42
v_dot2_f32_bf16 v41, v121, s51, v41
v_dot2_f32_bf16 v43, v121, v121, v43
v_dot2_f32_bf16 v40, v122, s51, v40
v_dot2_f32_bf16 v42, v122, v122, v42
v_dot2_f32_bf16 v41, v123, s51, v41
v_dot2_f32_bf16 v43, v123, v123, v43
v_dot2_f32_bf16 v44, v124, s51, v44
v_dot2_f32_bf16 v46, v124, v124, v46
v_dot2_f32_bf16 v45, v125, s51, v45
v_dot2_f32_bf16 v47, v125, v125, v47
v_dot2_f32_bf16 v44, v126, s51, v44
v_dot2_f32_bf16 v46, v126, v126, v46
v_dot2_f32_bf16 v45, v127, s51, v45
v_dot2_f32_bf16 v47, v127, v127, v47
s_waitcnt vmcnt(9)
v_dot2_f32_bf16 v40, v128, s51, v40
v_dot2_f32_bf16 v42, v128, v128, v42
v_dot2_f32_bf16 v41, v129, s51, v41
v_dot2_f32_bf16 v43, v129, v129, v43
v_dot2_f32_bf16 v40, v130, s51, v40
v_dot2_f32_bf16 v42, v130, v130, v42
v_dot2_f32_bf16 v41, v131, s51, v41
v_dot2_f32_bf16 v43, v131, v131, v43
v_dot2_f32_bf16 v44, v132, s51, v44
v_dot2_f32_bf16 v46, v132, v132, v46
v_dot2_f32_bf16 v45, v133, s51, v45
v_dot2_f32_bf16 v47, v133, v133, v47
v_dot2_f32_bf16 v44, v134, s51, v44
v_dot2_f32_bf16 v46, v134, v134, v46
v_dot2_f32_bf16 v45, v135, s51, v45
v_dot2_f32_bf16 v47, v135, v135, v47
s_waitcnt vmcnt(7)
v_dot2_f32_bf16 v40, v136, s51, v40
v_dot2_f32_bf16 v42, v136, v136, v42
v_dot2_f32_bf16 v41, v137, s51, v41
v_dot2_f32_bf16 v43, v137, v137, v43
v_dot2_f32_bf16 v40, v138, s51, v40
v_dot2_f32_bf16 v42, v138, v138, v42
v_dot2_f32_bf16 v41, v139, s51, v41
v_dot2_f32_bf16 v43, v139, v139, v43
v_dot2_f32_bf16 v44, v140, s51, v44
v_dot2_f32_bf16 v46, v140, v140, v46
v_dot2_f32_bf16 v45, v141, s51, v45
v_dot2_f32_bf16 v47, v141, v141, v47
v_dot2_f32_bf16 v44, v142, s51, v44
v_dot2_f32_bf16 v46, v142, v142, v46
v_dot2_f32_bf16 v45, v143, s51, v45
v_dot2_f32_bf16 v47, v143, v143, v47
s_waitcnt vmcnt(5)
v_dot2_f32_bf16 v40, v144, s51, v40
v_dot2_f32_bf16 v42, v144, v144, v42
v_dot2_f32_bf16 v41, v145, s51, v41
v_dot2_f32_bf16 v43, v145, v145, v43
v_dot2_f32_bf16 v40, v146, s51, v40
v_dot2_f32_bf16 v42, v146, v146, v42
v_dot2_f32_bf16 v41, v147, s51, v41
v_dot2_f32_bf16 v43, v147, v147, v43
v_dot2_f32_bf16 v44, v148, s51, v44
v_dot2_f32_bf16 v46, v148, v148, v46
v_dot2_f32_bf16 v45, v149, s51, v45
v_dot2_f32_bf16 v47, v149, v149, v47
v_dot2_f32_bf16 v44, v150, s51, v44
v_dot2_f32_bf16 v46, v150, v150, v46
v_dot2_f32_bf16 v45, v151, s51, v45
v_dot2_f32_bf16 v47, v151, v151, v47
s_waitcnt vmcnt(3)
v_dot2_f32_bf16 v40, v152, s51, v40
v_dot2_f32_bf16 v42, v152, v152, v42
v_dot2_f32_bf16 v41, v153, s51, v41
v_dot2_f32_bf16 v43, v153, v153, v43
v_dot2_f32_bf16 v40, v154, s51, v40
v_dot2_f32_bf16 v42, v154, v154, v42
v_dot2_f32_bf16 v41, v155, s51, v41
v_dot2_f32_bf16 v43, v155, v155, v43
v_dot2_f32_bf16 v44, v156, s51, v44
v_dot2_f32_bf16 v46, v156, v156, v46
v_dot2_f32_bf16 v45, v157, s51, v45
v_dot2_f32_bf16 v47, v157, v157, v47
v_dot2_f32_bf16 v44, v158, s51, v44
v_dot2_f32_bf16 v46, v158, v158, v46
v_dot2_f32_bf16 v45, v159, s51, v45
v_dot2_f32_bf16 v47, v159, v159, v47
v_add_f32 v40, v40, v41
v_add_f32 v42, v42, v43
v_add_f32 v44, v44, v45
v_add_f32 v46, v46, v47
s_nop 1
v_add_f32_dpp v40, v40, v40 quad_perm:[1,0,3,2] row_mask:0xf bank_mask:0xf
v_add_f32_dpp v42, v42, v42 quad_perm:[1,0,3,2] row_mask:0xf bank_mask:0xf
v_add_f32_dpp v44, v44, v44 quad_perm:[1,0,3,2] row_mask:0xf bank_mask:0xf
v_add_f32_dpp v46, v46, v46 quad_perm:[1,0,3,2] row_mask:0xf bank_mask:0xf
s_nop 1
v_add_f32_dpp v40, v40, v40 quad_perm:[2,3,0,1] row_mask:0xf bank_mask:0xf
v_add_f32_dpp v42, v42, v42 quad_perm:[2,3,0,1] row_mask:0xf bank_mask:0xf
v_add_f32_dpp v44, v44, v44 quad_perm:[2,3,0,1] row_mask:0xf bank_mask:0xf
v_add_f32_dpp v46, v46, v46 quad_perm:[2,3,0,1] row_mask:0xf bank_mask:0xf
s_nop 1
v_add_f32_dpp v40, v40, v40 row_half_mirror row_mask:0xf bank_mask:0xf
v_add_f32_dpp v42, v42, v42 row_half_mirror row_mask:0xf bank_mask:0xf
v_add_f32_dpp v44, v44, v44 row_half_mirror row_mask:0xf bank_mask:0xf
v_add_f32_dpp v46, v46, v46 row_half_mirror row_mask:0xf bank_mask:0xf
s_mov_b32 s45, 0x3acccccd
s_mov_b32 s49, 0x3727c5ac
v_mul_f32 v40, s45, v40
v_mul_f32 v42, s45, v42
v_mul_f32 v44, s45, v44
v_mul_f32 v46, s45, v46
v_fma_f32 v42, -v40, v40, v42
v_fma_f32 v46, -v44, v44, v46
v_max_f32 v42, 0, v42
v_max_f32 v46, 0, v46
v_add_f32 v42, s49, v42
v_add_f32 v46, s49, v46
v_rsq_f32 v18, v42
v_rsq_f32 v19, v46
s_nop 0
v_mul_f32 v20, v40, v18
v_mul_f32 v23, v44, v19
v_sub_f32 v20, 0, v20
v_sub_f32 v23, 0, v23
v_lshlrev_b32 v24, 16, v80
v_and_b32 v25, s50, v80
v_lshlrev_b32 v26, 16, v81
v_and_b32 v27, s50, v81
v_lshlrev_b32 v28, 16, v82
v_and_b32 v29, s50, v82
v_lshlrev_b32 v30, 16, v83
v_and_b32 v31, s50, v83
v_fma_f32 v24, v24, v18, v20
v_fma_f32 v25, v25, v18, v20
v_fma_f32 v26, v26, v18, v20
v_fma_f32 v27, v27, v18, v20
v_fma_f32 v28, v28, v18, v20
v_fma_f32 v29, v29, v18, v20
v_fma_f32 v30, v30, v18, v20
v_fma_f32 v31, v31, v18, v20
v_cvt_pk_bf16_f32 v32, v24, v25
v_cvt_pk_bf16_f32 v33, v26, v27
v_cvt_pk_bf16_f32 v34, v28, v29
v_cvt_pk_bf16_f32 v35, v30, v31
ds_write_b128 v14, v[32:35] offset:0
v_lshlrev_b32 v24, 16, v84
v_and_b32 v25, s50, v84
v_lshlrev_b32 v26, 16, v85
v_and_b32 v27, s50, v85
v_lshlrev_b32 v28, 16, v86
v_and_b32 v29, s50, v86
v_lshlrev_b32 v30, 16, v87
v_and_b32 v31, s50, v87
v_fma_f32 v24, v24, v19, v23
v_fma_f32 v25, v25, v19, v23
v_fma_f32 v26, v26, v19, v23
v_fma_f32 v27, v27, v19, v23
v_fma_f32 v28, v28, v19, v23
v_fma_f32 v29, v29, v19, v23
v_fma_f32 v30, v30, v19, v23
v_fma_f32 v31, v31, v19, v23
v_cvt_pk_bf16_f32 v36, v24, v25
v_cvt_pk_bf16_f32 v37, v26, v27
v_cvt_pk_bf16_f32 v38, v28, v29
v_cvt_pk_bf16_f32 v39, v30, v31
ds_write_b128 v15, v[36:39] offset:0
s_add_u32 m0, s44, 24832
s_nop 0
buffer_load_dwordx4 v2, s[12:15], s65 offen lds
s_add_u32 m0, s44, 25856
s_nop 0
buffer_load_dwordx4 v3, s[12:15], s65 offen lds
s_add_u32 m0, s44, 26880
s_nop 0
buffer_load_dwordx4 v4, s[12:15], s65 offen lds
s_add_u32 m0, s44, 49664
s_nop 0
buffer_load_dwordx4 v2, s[12:15], s66 offen lds
s_add_u32 m0, s44, 50688
s_nop 0
buffer_load_dwordx4 v3, s[12:15], s66 offen lds
s_add_u32 m0, s44, 51712
s_nop 0
buffer_load_dwordx4 v4, s[12:15], s66 offen lds
s_add_u32 m0, s44, 74496
s_nop 0
buffer_load_dwordx4 v2, s[12:15], s67 offen lds
s_add_u32 m0, s44, 75520
s_nop 0
buffer_load_dwordx4 v3, s[12:15], s67 offen lds
s_add_u32 m0, s44, 76544
s_nop 0
buffer_load_dwordx4 v4, s[12:15], s67 offen lds
v_lshlrev_b32 v24, 16, v88
v_and_b32 v25, s50, v88
v_lshlrev_b32 v26, 16, v89
v_and_b32 v27, s50, v89
v_lshlrev_b32 v28, 16, v90
v_and_b32 v29, s50, v90
v_lshlrev_b32 v30, 16, v91
v_and_b32 v31, s50, v91
v_fma_f32 v24, v24, v18, v20
v_fma_f32 v25, v25, v18, v20
v_fma_f32 v26, v26, v18, v20
v_fma_f32 v27, v27, v18, v20
v_fma_f32 v28, v28, v18, v20
v_fma_f32 v29, v29, v18, v20
v_fma_f32 v30, v30, v18, v20
v_fma_f32 v31, v31, v18, v20
v_cvt_pk_bf16_f32 v32, v24, v25
v_cvt_pk_bf16_f32 v33, v26, v27
v_cvt_pk_bf16_f32 v34, v28, v29
v_cvt_pk_bf16_f32 v35, v30, v31
s_waitcnt vmcnt(9) lgkmcnt(0)
s_cmp_eq_u32 s54, 0
s_cbranch_scc1 L_g0_1
s_barrier
L_g0_1:
s_barrier
ds_read_b128 v[40:43], v10 offset:0
ds_read_b128 v[44:47], v10 offset:4096
ds_read_b64_tr_b16 v[48:49], v6 offset:0
ds_read_b64_tr_b16 v[50:51], v6 offset:1536
ds_read_b64_tr_b16 v[52:53], v6 offset:512
ds_read_b64_tr_b16 v[54:55], v6 offset:2048
ds_read_b64_tr_b16 v[56:57], v6 offset:1024
ds_read_b64_tr_b16 v[58:59], v6 offset:2560
ds_read_b128 v[60:63], v11 offset:0
ds_read_b128 v[64:67], v11 offset:4096
ds_read_b64_tr_b16 v[68:69], v6 offset:6144
ds_read_b64_tr_b16 v[70:71], v6 offset:7680
ds_read_b64_tr_b16 v[72:73], v6 offset:6656
ds_read_b64_tr_b16 v[74:75], v6 offset:8192
ds_read_b64_tr_b16 v[76:77], v6 offset:7168
ds_read_b64_tr_b16 v[78:79], v6 offset:8704
ds_write_b128 v14, v[32:35] offset:16384
s_add_u32 m0, s44, 99328
s_nop 0
buffer_load_dwordx4 v2, s[12:15], s68 offen lds
s_add_u32 m0, s44, 100352
s_nop 0
buffer_load_dwordx4 v3, s[12:15], s68 offen lds
s_add_u32 m0, s44, 101376
s_nop 0
buffer_load_dwordx4 v4, s[12:15], s68 offen lds
s_waitcnt vmcnt(9) lgkmcnt(0)
s_barrier
s_setprio 1
.p2align 3
v_mfma_f32_32x32x16_bf16 v[160:175], v[48:51], v[40:43], 0
v_lshlrev_b32 v24, 16, v92
v_and_b32 v25, s50, v92
v_lshlrev_b32 v26, 16, v93
v_and_b32 v27, s50, v93
v_mfma_f32_32x32x16_bf16 v[208:223], v[48:51], v[44:47], 0
v_lshlrev_b32 v28, 16, v94
v_and_b32 v29, s50, v94
v_lshlrev_b32 v30, 16, v95
v_and_b32 v31, s50, v95
v_fma_f32 v24, v24, v19, v23
v_mfma_f32_32x32x16_bf16 v[176:191], v[52:55], v[40:43], 0
v_fma_f32 v25, v25, v19, v23
v_fma_f32 v26, v26, v19, v23
v_mfma_f32_32x32x16_bf16 v[224:239], v[52:55], v[44:47], 0
v_fma_f32 v27, v27, v19, v23
v_fma_f32 v28, v28, v19, v23
v_fma_f32 v29, v29, v19, v23
v_mfma_f32_32x32x16_bf16 v[192:207], v[56:59], v[40:43], 0
v_fma_f32 v30, v30, v19, v23
v_fma_f32 v31, v31, v19, v23
v_mfma_f32_32x32x16_bf16 v[240:255], v[56:59], v[44:47], 0
v_cvt_pk_bf16_f32 v36, v24, v25
v_cvt_pk_bf16_f32 v37, v26, v27
v_cvt_pk_bf16_f32 v38, v28, v29
v_mfma_f32_32x32x16_bf16 v[160:175], v[68:71], v[60:63], v[160:175]
v_cvt_pk_bf16_f32 v39, v30, v31
s_add_u32 s69, s68, 98304
s_cmp_eq_u32 s69, 1966080
s_cselect_b32 s69, 0, s69
s_add_u32 s70, s69, 98304
s_cmp_eq_u32 s70, 1966080
s_cselect_b32 s70, 0, s70
v_mfma_f32_32x32x16_bf16 v[208:223], v[68:71], v[64:67], v[208:223]
s_add_u32 s71, s70, 98304
s_cmp_eq_u32 s71, 1966080
s_cselect_b32 s71, 0, s71
s_add_u32 s72, s71, 98304
s_cmp_eq_u32 s72, 1966080
s_cselect_b32 s72, 0, s72
v_mfma_f32_32x32x16_bf16 v[176:191], v[72:75], v[60:63], v[176:191]
s_add_u32 s73, s72, 98304
s_cmp_eq_u32 s73, 1966080
s_cselect_b32 s73, 0, s73
s_add_u32 s74, s73, 98304
s_cmp_eq_u32 s74, 1966080
s_cselect_b32 s74, 0, s74
s_add_u32 s75, s74, 98304
s_cmp_eq_u32 s75, 1966080
s_cselect_b32 s75, 0, s75
v_mfma_f32_32x32x16_bf16 v[224:239], v[72:75], v[64:67], v[224:239]
s_add_u32 s76, s75, 98304
s_cmp_eq_u32 s76, 1966080
s_cselect_b32 s76, 0, s76
s_add_u32 s77, s76, 98304
s_cmp_eq_u32 s77, 1966080
s_cselect_b32 s77, 0, s77
v_mfma_f32_32x32x16_bf16 v[192:207], v[76:79], v[60:63], v[192:207]
s_add_u32 s78, s77, 98304
s_cmp_eq_u32 s78, 1966080
s_cselect_b32 s78, 0, s78
s_add_u32 s79, s78, 98304
s_cmp_eq_u32 s79, 1966080
s_cselect_b32 s79, 0, s79
s_add_u32 s80, s79, 98304
s_cmp_eq_u32 s80, 1966080
s_cselect_b32 s80, 0, s80
v_mfma_f32_32x32x16_bf16 v[240:255], v[76:79], v[64:67], v[240:255]
s_add_u32 s81, s80, 98304
s_cmp_eq_u32 s81, 1966080
s_cselect_b32 s81, 0, s81
s_add_u32 s82, s81, 98304
s_cmp_eq_u32 s82, 1966080
s_cselect_b32 s82, 0, s82
s_add_u32 s83, s82, 98304
s_cmp_eq_u32 s83, 1966080
s_cselect_b32 s83, 0, s83
s_setprio 0
s_barrier
ds_read_b128 v[40:43], v12 offset:0
ds_read_b128 v[44:47], v12 offset:4096
ds_read_b64_tr_b16 v[48:49], v6 offset:24832
ds_read_b64_tr_b16 v[50:51], v6 offset:26368
ds_read_b64_tr_b16 v[52:53], v6 offset:25344
ds_read_b64_tr_b16 v[54:55], v6 offset:26880
ds_read_b64_tr_b16 v[56:57], v6 offset:25856
ds_read_b64_tr_b16 v[58:59], v6 offset:27392
ds_read_b128 v[60:63], v13 offset:0
ds_read_b128 v[64:67], v13 offset:4096
ds_read_b64_tr_b16 v[68:69], v6 offset:30976
ds_read_b64_tr_b16 v[70:71], v6 offset:32512
ds_read_b64_tr_b16 v[72:73], v6 offset:31488
ds_read_b64_tr_b16 v[74:75], v6 offset:33024
ds_read_b64_tr_b16 v[76:77], v6 offset:32000
ds_read_b64_tr_b16 v[78:79], v6 offset:33536
ds_write_b128 v15, v[36:39] offset:16384
s_add_u32 m0, s44, 0
s_nop 0
buffer_load_dwordx4 v2, s[12:15], s69 offen lds
s_add_u32 m0, s44, 1024
s_nop 0
buffer_load_dwordx4 v3, s[12:15], s69 offen lds
s_add_u32 m0, s44, 2048
s_nop 0
buffer_load_dwordx4 v4, s[12:15], s69 offen lds
s_waitcnt vmcnt(9) lgkmcnt(0)
s_barrier
s_setprio 1
.p2align 3
v_mfma_f32_32x32x16_bf16 v[160:175], v[48:51], v[40:43], v[160:175]
v_lshlrev_b32 v24, 16, v96
v_and_b32 v25, s50, v96
v_mfma_f32_32x32x16_bf16 v[208:223], v[48:51], v[44:47], v[208:223]
v_lshlrev_b32 v26, 16, v97
v_and_b32 v27, s50, v97
v_mfma_f32_32x32x16_bf16 v[176:191], v[52:55], v[40:43], v[176:191]
v_lshlrev_b32 v28, 16, v98
v_and_b32 v29, s50, v98
v_lshlrev_b32 v30, 16, v99
v_and_b32 v31, s50, v99
v_mfma_f32_32x32x16_bf16 v[224:239], v[52:55], v[44:47], v[224:239]
v_fma_f32 v24, v24, v18, v20
v_mfma_f32_32x32x16_bf16 v[192:207], v[56:59], v[40:43], v[192:207]
v_fma_f32 v25, v25, v18, v20
v_mfma_f32_32x32x16_bf16 v[240:255], v[56:59], v[44:47], v[240:255]
v_fma_f32 v26, v26, v18, v20
v_fma_f32 v27, v27, v18, v20
v_mfma_f32_32x32x16_bf16 v[160:175], v[68:71], v[60:63], v[160:175]
v_fma_f32 v28, v28, v18, v20
v_mfma_f32_32x32x16_bf16 v[208:223], v[68:71], v[64:67], v[208:223]
v_fma_f32 v29, v29, v18, v20
v_mfma_f32_32x32x16_bf16 v[176:191], v[72:75], v[60:63], v[176:191]
v_fma_f32 v30, v30, v18, v20
v_fma_f32 v31, v31, v18, v20
v_mfma_f32_32x32x16_bf16 v[224:239], v[72:75], v[64:67], v[224:239]
v_cvt_pk_bf16_f32 v32, v24, v25
v_mfma_f32_32x32x16_bf16 v[192:207], v[76:79], v[60:63], v[192:207]
v_cvt_pk_bf16_f32 v33, v26, v27
v_mfma_f32_32x32x16_bf16 v[240:255], v[76:79], v[64:67], v[240:255]
v_cvt_pk_bf16_f32 v34, v28, v29
v_cvt_pk_bf16_f32 v35, v30, v31
s_setprio 0
s_barrier
ds_read_b128 v[40:43], v10 offset:16384
ds_read_b128 v[44:47], v10 offset:20480
ds_read_b64_tr_b16 v[48:49], v7 offset:0
ds_read_b64_tr_b16 v[50:51], v7 offset:1536
ds_read_b64_tr_b16 v[52:53], v7 offset:512
ds_read_b64_tr_b16 v[54:55], v7 offset:2048
ds_read_b64_tr_b16 v[56:57], v7 offset:1024
ds_read_b64_tr_b16 v[58:59], v7 offset:2560
ds_read_b128 v[60:63], v11 offset:16384
ds_read_b128 v[64:67], v11 offset:20480
ds_read_b64_tr_b16 v[68:69], v7 offset:6144
ds_read_b64_tr_b16 v[70:71], v7 offset:7680
ds_read_b64_tr_b16 v[72:73], v7 offset:6656
ds_read_b64_tr_b16 v[74:75], v7 offset:8192
ds_read_b64_tr_b16 v[76:77], v7 offset:7168
ds_read_b64_tr_b16 v[78:79], v7 offset:8704
ds_write_b128 v14, v[32:35] offset:0
s_add_u32 m0, s44, 24832
s_nop 0
buffer_load_dwordx4 v2, s[12:15], s70 offen lds
s_add_u32 m0, s44, 25856
s_nop 0
buffer_load_dwordx4 v3, s[12:15], s70 offen lds
s_add_u32 m0, s44, 26880
s_nop 0
buffer_load_dwordx4 v4, s[12:15], s70 offen lds
s_waitcnt vmcnt(9) lgkmcnt(0)
s_barrier
s_setprio 1
.p2align 3
v_mfma_f32_32x32x16_bf16 v[160:175], v[48:51], v[40:43], v[160:175]
v_lshlrev_b32 v24, 16, v100
v_and_b32 v25, s50, v100
v_mfma_f32_32x32x16_bf16 v[208:223], v[48:51], v[44:47], v[208:223]
v_lshlrev_b32 v26, 16, v101
v_and_b32 v27, s50, v101
v_mfma_f32_32x32x16_bf16 v[176:191], v[52:55], v[40:43], v[176:191]
v_lshlrev_b32 v28, 16, v102
v_and_b32 v29, s50, v102
v_lshlrev_b32 v30, 16, v103
v_and_b32 v31, s50, v103
v_mfma_f32_32x32x16_bf16 v[224:239], v[52:55], v[44:47], v[224:239]
v_fma_f32 v24, v24, v19, v23
v_mfma_f32_32x32x16_bf16 v[192:207], v[56:59], v[40:43], v[192:207]
v_fma_f32 v25, v25, v19, v23
v_mfma_f32_32x32x16_bf16 v[240:255], v[56:59], v[44:47], v[240:255]
v_fma_f32 v26, v26, v19, v23
v_fma_f32 v27, v27, v19, v23
v_mfma_f32_32x32x16_bf16 v[160:175], v[68:71], v[60:63], v[160:175]
v_fma_f32 v28, v28, v19, v23
v_mfma_f32_32x32x16_bf16 v[208:223], v[68:71], v[64:67], v[208:223]
v_fma_f32 v29, v29, v19, v23
v_mfma_f32_32x32x16_bf16 v[176:191], v[72:75], v[60:63], v[176:191]
v_fma_f32 v30, v30, v19, v23
v_fma_f32 v31, v31, v19, v23
v_mfma_f32_32x32x16_bf16 v[224:239], v[72:75], v[64:67], v[224:239]
v_cvt_pk_bf16_f32 v36, v24, v25
v_mfma_f32_32x32x16_bf16 v[192:207], v[76:79], v[60:63], v[192:207]
v_cvt_pk_bf16_f32 v37, v26, v27
v_mfma_f32_32x32x16_bf16 v[240:255], v[76:79], v[64:67], v[240:255]
v_cvt_pk_bf16_f32 v38, v28, v29
v_cvt_pk_bf16_f32 v39, v30, v31
s_setprio 0
s_barrier
ds_read_b128 v[40:43], v12 offset:16384
ds_read_b128 v[44:47], v12 offset:20480
ds_read_b64_tr_b16 v[48:49], v7 offset:24832
ds_read_b64_tr_b16 v[50:51], v7 offset:26368
ds_read_b64_tr_b16 v[52:53], v7 offset:25344
ds_read_b64_tr_b16 v[54:55], v7 offset:26880
ds_read_b64_tr_b16 v[56:57], v7 offset:25856
ds_read_b64_tr_b16 v[58:59], v7 offset:27392
ds_read_b128 v[60:63], v13 offset:16384
ds_read_b128 v[64:67], v13 offset:20480
ds_read_b64_tr_b16 v[68:69], v7 offset:30976
ds_read_b64_tr_b16 v[70:71], v7 offset:32512
ds_read_b64_tr_b16 v[72:73], v7 offset:31488
ds_read_b64_tr_b16 v[74:75], v7 offset:33024
ds_read_b64_tr_b16 v[76:77], v7 offset:32000
ds_read_b64_tr_b16 v[78:79], v7 offset:33536
ds_write_b128 v15, v[36:39] offset:0
s_add_u32 m0, s44, 49664
s_nop 0
buffer_load_dwordx4 v2, s[12:15], s71 offen lds
s_add_u32 m0, s44, 50688
s_nop 0
buffer_load_dwordx4 v3, s[12:15], s71 offen lds
s_add_u32 m0, s44, 51712
s_nop 0
buffer_load_dwordx4 v4, s[12:15], s71 offen lds
s_waitcnt vmcnt(9) lgkmcnt(0)
s_barrier
s_setprio 1
.p2align 3
v_mfma_f32_32x32x16_bf16 v[160:175], v[48:51], v[40:43], v[160:175]
v_lshlrev_b32 v24, 16, v104
v_and_b32 v25, s50, v104
v_mfma_f32_32x32x16_bf16 v[208:223], v[48:51], v[44:47], v[208:223]
v_lshlrev_b32 v26, 16, v105
v_and_b32 v27, s50, v105
v_mfma_f32_32x32x16_bf16 v[176:191], v[52:55], v[40:43], v[176:191]
v_lshlrev_b32 v28, 16, v106
v_and_b32 v29, s50, v106
v_lshlrev_b32 v30, 16, v107
v_and_b32 v31, s50, v107
v_mfma_f32_32x32x16_bf16 v[224:239], v[52:55], v[44:47], v[224:239]
v_fma_f32 v24, v24, v18, v20
v_mfma_f32_32x32x16_bf16 v[192:207], v[56:59], v[40:43], v[192:207]
v_fma_f32 v25, v25, v18, v20
v_mfma_f32_32x32x16_bf16 v[240:255], v[56:59], v[44:47], v[240:255]
v_fma_f32 v26, v26, v18, v20
v_fma_f32 v27, v27, v18, v20
v_mfma_f32_32x32x16_bf16 v[160:175], v[68:71], v[60:63], v[160:175]
v_fma_f32 v28, v28, v18, v20
v_mfma_f32_32x32x16_bf16 v[208:223], v[68:71], v[64:67], v[208:223]
v_fma_f32 v29, v29, v18, v20
v_mfma_f32_32x32x16_bf16 v[176:191], v[72:75], v[60:63], v[176:191]
v_fma_f32 v30, v30, v18, v20
v_fma_f32 v31, v31, v18, v20
v_mfma_f32_32x32x16_bf16 v[224:239], v[72:75], v[64:67], v[224:239]
v_cvt_pk_bf16_f32 v32, v24, v25
v_mfma_f32_32x32x16_bf16 v[192:207], v[76:79], v[60:63], v[192:207]
v_cvt_pk_bf16_f32 v33, v26, v27
v_mfma_f32_32x32x16_bf16 v[240:255], v[76:79], v[64:67], v[240:255]
v_cvt_pk_bf16_f32 v34, v28, v29
v_cvt_pk_bf16_f32 v35, v30, v31
s_setprio 0
s_barrier
ds_read_b128 v[40:43], v10 offset:0
ds_read_b128 v[44:47], v10 offset:4096
ds_read_b64_tr_b16 v[48:49], v8 offset:0
ds_read_b64_tr_b16 v[50:51], v8 offset:1536
ds_read_b64_tr_b16 v[52:53], v8 offset:512
ds_read_b64_tr_b16 v[54:55], v8 offset:2048
ds_read_b64_tr_b16 v[56:57], v8 offset:1024
ds_read_b64_tr_b16 v[58:59], v8 offset:2560
ds_read_b128 v[60:63], v11 offset:0
ds_read_b128 v[64:67], v11 offset:4096
ds_read_b64_tr_b16 v[68:69], v8 offset:6144
ds_read_b64_tr_b16 v[70:71], v8 offset:7680
ds_read_b64_tr_b16 v[72:73], v8 offset:6656
ds_read_b64_tr_b16 v[74:75], v8 offset:8192
ds_read_b64_tr_b16 v[76:77], v8 offset:7168
ds_read_b64_tr_b16 v[78:79], v8 offset:8704
ds_write_b128 v14, v[32:35] offset:16384
s_add_u32 m0, s44, 74496
s_nop 0
buffer_load_dwordx4 v2, s[12:15], s72 offen lds
s_add_u32 m0, s44, 75520
s_nop 0
buffer_load_dwordx4 v3, s[12:15], s72 offen lds
s_add_u32 m0, s44, 76544
s_nop 0
buffer_load_dwordx4 v4, s[12:15], s72 offen lds
s_waitcnt vmcnt(9) lgkmcnt(0)
s_barrier
s_setprio 1
.p2align 3
v_mfma_f32_32x32x16_bf16 v[160:175], v[48:51], v[40:43], v[160:175]
v_lshlrev_b32 v24, 16, v108
v_and_b32 v25, s50, v108
v_mfma_f32_32x32x16_bf16 v[208:223], v[48:51], v[44:47], v[208:223]
v_lshlrev_b32 v26, 16, v109
v_and_b32 v27, s50, v109
v_mfma_f32_32x32x16_bf16 v[176:191], v[52:55], v[40:43], v[176:191]
v_lshlrev_b32 v28, 16, v110
v_and_b32 v29, s50, v110
v_lshlrev_b32 v30, 16, v111
v_and_b32 v31, s50, v111
v_mfma_f32_32x32x16_bf16 v[224:239], v[52:55], v[44:47], v[224:239]
v_fma_f32 v24, v24, v19, v23
v_mfma_f32_32x32x16_bf16 v[192:207], v[56:59], v[40:43], v[192:207]
v_fma_f32 v25, v25, v19, v23
v_mfma_f32_32x32x16_bf16 v[240:255], v[56:59], v[44:47], v[240:255]
v_fma_f32 v26, v26, v19, v23
v_fma_f32 v27, v27, v19, v23
v_mfma_f32_32x32x16_bf16 v[160:175], v[68:71], v[60:63], v[160:175]
v_fma_f32 v28, v28, v19, v23
v_mfma_f32_32x32x16_bf16 v[208:223], v[68:71], v[64:67], v[208:223]
v_fma_f32 v29, v29, v19, v23
v_mfma_f32_32x32x16_bf16 v[176:191], v[72:75], v[60:63], v[176:191]
v_fma_f32 v30, v30, v19, v23
v_fma_f32 v31, v31, v19, v23
v_mfma_f32_32x32x16_bf16 v[224:239], v[72:75], v[64:67], v[224:239]
v_cvt_pk_bf16_f32 v36, v24, v25
v_mfma_f32_32x32x16_bf16 v[192:207], v[76:79], v[60:63], v[192:207]
v_cvt_pk_bf16_f32 v37, v26, v27
v_mfma_f32_32x32x16_bf16 v[240:255], v[76:79], v[64:67], v[240:255]
v_cvt_pk_bf16_f32 v38, v28, v29
v_cvt_pk_bf16_f32 v39, v30, v31
s_setprio 0
s_barrier
ds_read_b128 v[40:43], v12 offset:0
ds_read_b128 v[44:47], v12 offset:4096
ds_read_b64_tr_b16 v[48:49], v6 offset:0
ds_read_b64_tr_b16 v[50:51], v6 offset:1536
ds_read_b64_tr_b16 v[52:53], v6 offset:512
ds_read_b64_tr_b16 v[54:55], v6 offset:2048
ds_read_b64_tr_b16 v[56:57], v6 offset:1024
ds_read_b64_tr_b16 v[58:59], v6 offset:2560
ds_read_b128 v[60:63], v13 offset:0
ds_read_b128 v[64:67], v13 offset:4096
ds_read_b64_tr_b16 v[68:69], v6 offset:6144
ds_read_b64_tr_b16 v[70:71], v6 offset:7680
ds_read_b64_tr_b16 v[72:73], v6 offset:6656
ds_read_b64_tr_b16 v[74:75], v6 offset:8192
ds_read_b64_tr_b16 v[76:77], v6 offset:7168
ds_read_b64_tr_b16 v[78:79], v6 offset:8704
ds_write_b128 v15, v[36:39] offset:16384
s_add_u32 m0, s44, 99328
s_nop 0
buffer_load_dwordx4 v2, s[12:15], s73 offen lds
s_add_u32 m0, s44, 100352
s_nop 0
buffer_load_dwordx4 v3, s[12:15], s73 offen lds
s_add_u32 m0, s44, 101376
s_nop 0
buffer_load_dwordx4 v4, s[12:15], s73 offen lds
s_waitcnt vmcnt(9) lgkmcnt(0)
s_barrier
s_setprio 1
.p2align 3
v_mfma_f32_32x32x16_bf16 v[160:175], v[48:51], v[40:43], v[160:175]
v_lshlrev_b32 v24, 16, v112
v_and_b32 v25, s50, v112
v_mfma_f32_32x32x16_bf16 v[208:223], v[48:51], v[44:47], v[208:223]
v_lshlrev_b32 v26, 16, v113
v_and_b32 v27, s50, v113
v_mfma_f32_32x32x16_bf16 v[176:191], v[52:55], v[40:43], v[176:191]
v_lshlrev_b32 v28, 16, v114
v_and_b32 v29, s50, v114
v_lshlrev_b32 v30, 16, v115
v_and_b32 v31, s50, v115
v_mfma_f32_32x32x16_bf16 v[224:239], v[52:55], v[44:47], v[224:239]
v_fma_f32 v24, v24, v18, v20
v_mfma_f32_32x32x16_bf16 v[192:207], v[56:59], v[40:43], v[192:207]
v_fma_f32 v25, v25, v18, v20
v_mfma_f32_32x32x16_bf16 v[240:255], v[56:59], v[44:47], v[240:255]
v_fma_f32 v26, v26, v18, v20
v_fma_f32 v27, v27, v18, v20
v_mfma_f32_32x32x16_bf16 v[160:175], v[68:71], v[60:63], v[160:175]
v_fma_f32 v28, v28, v18, v20
v_mfma_f32_32x32x16_bf16 v[208:223], v[68:71], v[64:67], v[208:223]
v_fma_f32 v29, v29, v18, v20
v_mfma_f32_32x32x16_bf16 v[176:191], v[72:75], v[60:63], v[176:191]
v_fma_f32 v30, v30, v18, v20
v_fma_f32 v31, v31, v18, v20
v_mfma_f32_32x32x16_bf16 v[224:239], v[72:75], v[64:67], v[224:239]
v_cvt_pk_bf16_f32 v32, v24, v25
v_mfma_f32_32x32x16_bf16 v[192:207], v[76:79], v[60:63], v[192:207]
v_cvt_pk_bf16_f32 v33, v26, v27
v_mfma_f32_32x32x16_bf16 v[240:255], v[76:79], v[64:67], v[240:255]
v_cvt_pk_bf16_f32 v34, v28, v29
v_cvt_pk_bf16_f32 v35, v30, v31
s_setprio 0
s_barrier
ds_read_b128 v[40:43], v10 offset:16384
ds_read_b128 v[44:47], v10 offset:20480
ds_read_b64_tr_b16 v[48:49], v6 offset:24832
ds_read_b64_tr_b16 v[50:51], v6 offset:26368
ds_read_b64_tr_b16 v[52:53], v6 offset:25344
ds_read_b64_tr_b16 v[54:55], v6 offset:26880
ds_read_b64_tr_b16 v[56:57], v6 offset:25856
ds_read_b64_tr_b16 v[58:59], v6 offset:27392
ds_read_b128 v[60:63], v11 offset:16384
ds_read_b128 v[64:67], v11 offset:20480
ds_read_b64_tr_b16 v[68:69], v6 offset:30976
ds_read_b64_tr_b16 v[70:71], v6 offset:32512
ds_read_b64_tr_b16 v[72:73], v6 offset:31488
ds_read_b64_tr_b16 v[74:75], v6 offset:33024
ds_read_b64_tr_b16 v[76:77], v6 offset:32000
ds_read_b64_tr_b16 v[78:79], v6 offset:33536
ds_write_b128 v14, v[32:35] offset:0
s_add_u32 m0, s44, 0
s_nop 0
buffer_load_dwordx4 v2, s[12:15], s74 offen lds
s_add_u32 m0, s44, 1024
s_nop 0
buffer_load_dwordx4 v3, s[12:15], s74 offen lds
s_add_u32 m0, s44, 2048
s_nop 0
buffer_load_dwordx4 v4, s[12:15], s74 offen lds
s_waitcnt vmcnt(9) lgkmcnt(0)
s_barrier
s_setprio 1
.p2align 3
v_mfma_f32_32x32x16_bf16 v[160:175], v[48:51], v[40:43], v[160:175]
v_lshlrev_b32 v24, 16, v116
v_and_b32 v25, s50, v116
v_mfma_f32_32x32x16_bf16 v[208:223], v[48:51], v[44:47], v[208:223]
v_lshlrev_b32 v26, 16, v117
v_and_b32 v27, s50, v117
v_mfma_f32_32x32x16_bf16 v[176:191], v[52:55], v[40:43], v[176:191]
v_lshlrev_b32 v28, 16, v118
v_and_b32 v29, s50, v118
v_lshlrev_b32 v30, 16, v119
v_and_b32 v31, s50, v119
v_mfma_f32_32x32x16_bf16 v[224:239], v[52:55], v[44:47], v[224:239]
v_fma_f32 v24, v24, v19, v23
v_mfma_f32_32x32x16_bf16 v[192:207], v[56:59], v[40:43], v[192:207]
v_fma_f32 v25, v25, v19, v23
v_mfma_f32_32x32x16_bf16 v[240:255], v[56:59], v[44:47], v[240:255]
v_fma_f32 v26, v26, v19, v23
v_fma_f32 v27, v27, v19, v23
v_mfma_f32_32x32x16_bf16 v[160:175], v[68:71], v[60:63], v[160:175]
v_fma_f32 v28, v28, v19, v23
v_mfma_f32_32x32x16_bf16 v[208:223], v[68:71], v[64:67], v[208:223]
v_fma_f32 v29, v29, v19, v23
v_mfma_f32_32x32x16_bf16 v[176:191], v[72:75], v[60:63], v[176:191]
v_fma_f32 v30, v30, v19, v23
v_fma_f32 v31, v31, v19, v23
v_mfma_f32_32x32x16_bf16 v[224:239], v[72:75], v[64:67], v[224:239]
v_cvt_pk_bf16_f32 v36, v24, v25
v_mfma_f32_32x32x16_bf16 v[192:207], v[76:79], v[60:63], v[192:207]
v_cvt_pk_bf16_f32 v37, v26, v27
v_mfma_f32_32x32x16_bf16 v[240:255], v[76:79], v[64:67], v[240:255]
v_cvt_pk_bf16_f32 v38, v28, v29
v_cvt_pk_bf16_f32 v39, v30, v31
s_setprio 0
s_barrier
ds_read_b128 v[40:43], v12 offset:16384
ds_read_b128 v[44:47], v12 offset:20480
ds_read_b64_tr_b16 v[48:49], v7 offset:0
ds_read_b64_tr_b16 v[50:51], v7 offset:1536
ds_read_b64_tr_b16 v[52:53], v7 offset:512
ds_read_b64_tr_b16 v[54:55], v7 offset:2048
ds_read_b64_tr_b16 v[56:57], v7 offset:1024
ds_read_b64_tr_b16 v[58:59], v7 offset:2560
ds_read_b128 v[60:63], v13 offset:16384
ds_read_b128 v[64:67], v13 offset:20480
ds_read_b64_tr_b16 v[68:69], v7 offset:6144
ds_read_b64_tr_b16 v[70:71], v7 offset:7680
ds_read_b64_tr_b16 v[72:73], v7 offset:6656
ds_read_b64_tr_b16 v[74:75], v7 offset:8192
ds_read_b64_tr_b16 v[76:77], v7 offset:7168
ds_read_b64_tr_b16 v[78:79], v7 offset:8704
ds_write_b128 v15, v[36:39] offset:0
s_add_u32 m0, s44, 24832
s_nop 0
buffer_load_dwordx4 v2, s[12:15], s75 offen lds
s_add_u32 m0, s44, 25856
s_nop 0
buffer_load_dwordx4 v3, s[12:15], s75 offen lds
s_add_u32 m0, s44, 26880
s_nop 0
buffer_load_dwordx4 v4, s[12:15], s75 offen lds
s_waitcnt vmcnt(9) lgkmcnt(0)
s_barrier
s_setprio 1
.p2align 3
v_mfma_f32_32x32x16_bf16 v[160:175], v[48:51], v[40:43], v[160:175]
v_lshlrev_b32 v24, 16, v120
v_and_b32 v25, s50, v120
v_mfma_f32_32x32x16_bf16 v[208:223], v[48:51], v[44:47], v[208:223]
v_lshlrev_b32 v26, 16, v121
v_and_b32 v27, s50, v121
v_mfma_f32_32x32x16_bf16 v[176:191], v[52:55], v[40:43], v[176:191]
v_lshlrev_b32 v28, 16, v122
v_and_b32 v29, s50, v122
v_lshlrev_b32 v30, 16, v123
v_and_b32 v31, s50, v123
v_mfma_f32_32x32x16_bf16 v[224:239], v[52:55], v[44:47], v[224:239]
v_fma_f32 v24, v24, v18, v20
v_mfma_f32_32x32x16_bf16 v[192:207], v[56:59], v[40:43], v[192:207]
v_fma_f32 v25, v25, v18, v20
v_mfma_f32_32x32x16_bf16 v[240:255], v[56:59], v[44:47], v[240:255]
v_fma_f32 v26, v26, v18, v20
v_fma_f32 v27, v27, v18, v20
v_mfma_f32_32x32x16_bf16 v[160:175], v[68:71], v[60:63], v[160:175]
v_fma_f32 v28, v28, v18, v20
v_mfma_f32_32x32x16_bf16 v[208:223], v[68:71], v[64:67], v[208:223]
v_fma_f32 v29, v29, v18, v20
v_mfma_f32_32x32x16_bf16 v[176:191], v[72:75], v[60:63], v[176:191]
v_fma_f32 v30, v30, v18, v20
v_fma_f32 v31, v31, v18, v20
v_mfma_f32_32x32x16_bf16 v[224:239], v[72:75], v[64:67], v[224:239]
v_cvt_pk_bf16_f32 v32, v24, v25
v_mfma_f32_32x32x16_bf16 v[192:207], v[76:79], v[60:63], v[192:207]
v_cvt_pk_bf16_f32 v33, v26, v27
v_mfma_f32_32x32x16_bf16 v[240:255], v[76:79], v[64:67], v[240:255]
v_cvt_pk_bf16_f32 v34, v28, v29
v_cvt_pk_bf16_f32 v35, v30, v31
s_setprio 0
s_barrier
ds_read_b128 v[40:43], v10 offset:0
ds_read_b128 v[44:47], v10 offset:4096
ds_read_b64_tr_b16 v[48:49], v7 offset:24832
ds_read_b64_tr_b16 v[50:51], v7 offset:26368
ds_read_b64_tr_b16 v[52:53], v7 offset:25344
ds_read_b64_tr_b16 v[54:55], v7 offset:26880
ds_read_b64_tr_b16 v[56:57], v7 offset:25856
ds_read_b64_tr_b16 v[58:59], v7 offset:27392
ds_read_b128 v[60:63], v11 offset:0
ds_read_b128 v[64:67], v11 offset:4096
ds_read_b64_tr_b16 v[68:69], v7 offset:30976
ds_read_b64_tr_b16 v[70:71], v7 offset:32512
ds_read_b64_tr_b16 v[72:73], v7 offset:31488
ds_read_b64_tr_b16 v[74:75], v7 offset:33024
ds_read_b64_tr_b16 v[76:77], v7 offset:32000
ds_read_b64_tr_b16 v[78:79], v7 offset:33536
ds_write_b128 v14, v[32:35] offset:16384
s_add_u32 m0, s44, 49664
s_nop 0
buffer_load_dwordx4 v2, s[12:15], s76 offen lds
s_add_u32 m0, s44, 50688
s_nop 0
buffer_load_dwordx4 v3, s[12:15], s76 offen lds
s_add_u32 m0, s44, 51712
s_nop 0
buffer_load_dwordx4 v4, s[12:15], s76 offen lds
s_waitcnt vmcnt(9) lgkmcnt(0)
s_barrier
s_setprio 1
.p2align 3
v_mfma_f32_32x32x16_bf16 v[160:175], v[48:51], v[40:43], v[160:175]
v_lshlrev_b32 v24, 16, v124
v_and_b32 v25, s50, v124
v_mfma_f32_32x32x16_bf16 v[208:223], v[48:51], v[44:47], v[208:223]
v_lshlrev_b32 v26, 16, v125
v_and_b32 v27, s50, v125
v_mfma_f32_32x32x16_bf16 v[176:191], v[52:55], v[40:43], v[176:191]
v_lshlrev_b32 v28, 16, v126
v_and_b32 v29, s50, v126
v_lshlrev_b32 v30, 16, v127
v_and_b32 v31, s50, v127
v_mfma_f32_32x32x16_bf16 v[224:239], v[52:55], v[44:47], v[224:239]
v_fma_f32 v24, v24, v19, v23
v_mfma_f32_32x32x16_bf16 v[192:207], v[56:59], v[40:43], v[192:207]
v_fma_f32 v25, v25, v19, v23
v_mfma_f32_32x32x16_bf16 v[240:255], v[56:59], v[44:47], v[240:255]
v_fma_f32 v26, v26, v19, v23
v_fma_f32 v27, v27, v19, v23
v_mfma_f32_32x32x16_bf16 v[160:175], v[68:71], v[60:63], v[160:175]
v_fma_f32 v28, v28, v19, v23
v_mfma_f32_32x32x16_bf16 v[208:223], v[68:71], v[64:67], v[208:223]
v_fma_f32 v29, v29, v19, v23
v_mfma_f32_32x32x16_bf16 v[176:191], v[72:75], v[60:63], v[176:191]
v_fma_f32 v30, v30, v19, v23
v_fma_f32 v31, v31, v19, v23
v_mfma_f32_32x32x16_bf16 v[224:239], v[72:75], v[64:67], v[224:239]
v_cvt_pk_bf16_f32 v36, v24, v25
v_mfma_f32_32x32x16_bf16 v[192:207], v[76:79], v[60:63], v[192:207]
v_cvt_pk_bf16_f32 v37, v26, v27
v_mfma_f32_32x32x16_bf16 v[240:255], v[76:79], v[64:67], v[240:255]
v_cvt_pk_bf16_f32 v38, v28, v29
v_cvt_pk_bf16_f32 v39, v30, v31
s_setprio 0
s_barrier
ds_read_b128 v[40:43], v12 offset:0
ds_read_b128 v[44:47], v12 offset:4096
ds_read_b64_tr_b16 v[48:49], v8 offset:0
ds_read_b64_tr_b16 v[50:51], v8 offset:1536
ds_read_b64_tr_b16 v[52:53], v8 offset:512
ds_read_b64_tr_b16 v[54:55], v8 offset:2048
ds_read_b64_tr_b16 v[56:57], v8 offset:1024
ds_read_b64_tr_b16 v[58:59], v8 offset:2560
ds_read_b128 v[60:63], v13 offset:0
ds_read_b128 v[64:67], v13 offset:4096
ds_read_b64_tr_b16 v[68:69], v8 offset:6144
ds_read_b64_tr_b16 v[70:71], v8 offset:7680
ds_read_b64_tr_b16 v[72:73], v8 offset:6656
ds_read_b64_tr_b16 v[74:75], v8 offset:8192
ds_read_b64_tr_b16 v[76:77], v8 offset:7168
ds_read_b64_tr_b16 v[78:79], v8 offset:8704
ds_write_b128 v15, v[36:39] offset:16384
s_add_u32 m0, s44, 74496
s_nop 0
buffer_load_dwordx4 v2, s[12:15], s77 offen lds
s_add_u32 m0, s44, 75520
s_nop 0
buffer_load_dwordx4 v3, s[12:15], s77 offen lds
s_add_u32 m0, s44, 76544
s_nop 0
buffer_load_dwordx4 v4, s[12:15], s77 offen lds
s_waitcnt vmcnt(9) lgkmcnt(0)
s_barrier
s_setprio 1
.p2align 3
v_mfma_f32_32x32x16_bf16 v[160:175], v[48:51], v[40:43], v[160:175]
v_lshlrev_b32 v24, 16, v128
v_and_b32 v25, s50, v128
v_mfma_f32_32x32x16_bf16 v[208:223], v[48:51], v[44:47], v[208:223]
v_lshlrev_b32 v26, 16, v129
v_and_b32 v27, s50, v129
v_mfma_f32_32x32x16_bf16 v[176:191], v[52:55], v[40:43], v[176:191]
v_lshlrev_b32 v28, 16, v130
v_and_b32 v29, s50, v130
v_lshlrev_b32 v30, 16, v131
v_and_b32 v31, s50, v131
v_mfma_f32_32x32x16_bf16 v[224:239], v[52:55], v[44:47], v[224:239]
v_fma_f32 v24, v24, v18, v20
v_mfma_f32_32x32x16_bf16 v[192:207], v[56:59], v[40:43], v[192:207]
v_fma_f32 v25, v25, v18, v20
v_mfma_f32_32x32x16_bf16 v[240:255], v[56:59], v[44:47], v[240:255]
v_fma_f32 v26, v26, v18, v20
v_fma_f32 v27, v27, v18, v20
v_mfma_f32_32x32x16_bf16 v[160:175], v[68:71], v[60:63], v[160:175]
v_fma_f32 v28, v28, v18, v20
v_mfma_f32_32x32x16_bf16 v[208:223], v[68:71], v[64:67], v[208:223]
v_fma_f32 v29, v29, v18, v20
v_mfma_f32_32x32x16_bf16 v[176:191], v[72:75], v[60:63], v[176:191]
v_fma_f32 v30, v30, v18, v20
v_fma_f32 v31, v31, v18, v20
v_mfma_f32_32x32x16_bf16 v[224:239], v[72:75], v[64:67], v[224:239]
v_cvt_pk_bf16_f32 v32, v24, v25
v_mfma_f32_32x32x16_bf16 v[192:207], v[76:79], v[60:63], v[192:207]
v_cvt_pk_bf16_f32 v33, v26, v27
v_mfma_f32_32x32x16_bf16 v[240:255], v[76:79], v[64:67], v[240:255]
v_cvt_pk_bf16_f32 v34, v28, v29
v_cvt_pk_bf16_f32 v35, v30, v31
s_setprio 0
s_barrier
ds_read_b128 v[40:43], v10 offset:16384
ds_read_b128 v[44:47], v10 offset:20480
ds_read_b64_tr_b16 v[48:49], v6 offset:0
ds_read_b64_tr_b16 v[50:51], v6 offset:1536
ds_read_b64_tr_b16 v[52:53], v6 offset:512
ds_read_b64_tr_b16 v[54:55], v6 offset:2048
ds_read_b64_tr_b16 v[56:57], v6 offset:1024
ds_read_b64_tr_b16 v[58:59], v6 offset:2560
ds_read_b128 v[60:63], v11 offset:16384
ds_read_b128 v[64:67], v11 offset:20480
ds_read_b64_tr_b16 v[68:69], v6 offset:6144
ds_read_b64_tr_b16 v[70:71], v6 offset:7680
ds_read_b64_tr_b16 v[72:73], v6 offset:6656
ds_read_b64_tr_b16 v[74:75], v6 offset:8192
ds_read_b64_tr_b16 v[76:77], v6 offset:7168
ds_read_b64_tr_b16 v[78:79], v6 offset:8704
ds_write_b128 v14, v[32:35] offset:0
s_add_u32 m0, s44, 99328
s_nop 0
buffer_load_dwordx4 v2, s[12:15], s78 offen lds
s_add_u32 m0, s44, 100352
s_nop 0
buffer_load_dwordx4 v3, s[12:15], s78 offen lds
s_add_u32 m0, s44, 101376
s_nop 0
buffer_load_dwordx4 v4, s[12:15], s78 offen lds
s_waitcnt vmcnt(9) lgkmcnt(0)
s_barrier
s_setprio 1
.p2align 3
v_mfma_f32_32x32x16_bf16 v[160:175], v[48:51], v[40:43], v[160:175]
v_lshlrev_b32 v24, 16, v132
v_and_b32 v25, s50, v132
v_mfma_f32_32x32x16_bf16 v[208:223], v[48:51], v[44:47], v[208:223]
v_lshlrev_b32 v26, 16, v133
v_and_b32 v27, s50, v133
v_mfma_f32_32x32x16_bf16 v[176:191], v[52:55], v[40:43], v[176:191]
v_lshlrev_b32 v28, 16, v134
v_and_b32 v29, s50, v134
v_lshlrev_b32 v30, 16, v135
v_and_b32 v31, s50, v135
v_mfma_f32_32x32x16_bf16 v[224:239], v[52:55], v[44:47], v[224:239]
v_fma_f32 v24, v24, v19, v23
v_mfma_f32_32x32x16_bf16 v[192:207], v[56:59], v[40:43], v[192:207]
v_fma_f32 v25, v25, v19, v23
v_mfma_f32_32x32x16_bf16 v[240:255], v[56:59], v[44:47], v[240:255]
v_fma_f32 v26, v26, v19, v23
v_fma_f32 v27, v27, v19, v23
v_mfma_f32_32x32x16_bf16 v[160:175], v[68:71], v[60:63], v[160:175]
v_fma_f32 v28, v28, v19, v23
v_mfma_f32_32x32x16_bf16 v[208:223], v[68:71], v[64:67], v[208:223]
v_fma_f32 v29, v29, v19, v23
v_mfma_f32_32x32x16_bf16 v[176:191], v[72:75], v[60:63], v[176:191]
v_fma_f32 v30, v30, v19, v23
v_fma_f32 v31, v31, v19, v23
v_mfma_f32_32x32x16_bf16 v[224:239], v[72:75], v[64:67], v[224:239]
v_cvt_pk_bf16_f32 v36, v24, v25
v_mfma_f32_32x32x16_bf16 v[192:207], v[76:79], v[60:63], v[192:207]
v_cvt_pk_bf16_f32 v37, v26, v27
v_mfma_f32_32x32x16_bf16 v[240:255], v[76:79], v[64:67], v[240:255]
v_cvt_pk_bf16_f32 v38, v28, v29
v_cvt_pk_bf16_f32 v39, v30, v31
s_setprio 0
s_barrier
ds_read_b128 v[40:43], v12 offset:16384
ds_read_b128 v[44:47], v12 offset:20480
ds_read_b64_tr_b16 v[48:49], v6 offset:24832
ds_read_b64_tr_b16 v[50:51], v6 offset:26368
ds_read_b64_tr_b16 v[52:53], v6 offset:25344
ds_read_b64_tr_b16 v[54:55], v6 offset:26880
ds_read_b64_tr_b16 v[56:57], v6 offset:25856
ds_read_b64_tr_b16 v[58:59], v6 offset:27392
ds_read_b128 v[60:63], v13 offset:16384
ds_read_b128 v[64:67], v13 offset:20480
ds_read_b64_tr_b16 v[68:69], v6 offset:30976
ds_read_b64_tr_b16 v[70:71], v6 offset:32512
ds_read_b64_tr_b16 v[72:73], v6 offset:31488
ds_read_b64_tr_b16 v[74:75], v6 offset:33024
ds_read_b64_tr_b16 v[76:77], v6 offset:32000
ds_read_b64_tr_b16 v[78:79], v6 offset:33536
ds_write_b128 v15, v[36:39] offset:0
s_add_u32 m0, s44, 0
s_nop 0
buffer_load_dwordx4 v2, s[12:15], s79 offen lds
s_add_u32 m0, s44, 1024
s_nop 0
buffer_load_dwordx4 v3, s[12:15], s79 offen lds
s_add_u32 m0, s44, 2048
s_nop 0
buffer_load_dwordx4 v4, s[12:15], s79 offen lds
s_waitcnt vmcnt(9) lgkmcnt(0)
s_barrier
s_setprio 1
.p2align 3
v_mfma_f32_32x32x16_bf16 v[160:175], v[48:51], v[40:43], v[160:175]
v_lshlrev_b32 v24, 16, v136
v_and_b32 v25, s50, v136
v_mfma_f32_32x32x16_bf16 v[208:223], v[48:51], v[44:47], v[208:223]
v_lshlrev_b32 v26, 16, v137
v_and_b32 v27, s50, v137
v_mfma_f32_32x32x16_bf16 v[176:191], v[52:55], v[40:43], v[176:191]
v_lshlrev_b32 v28, 16, v138
v_and_b32 v29, s50, v138
v_lshlrev_b32 v30, 16, v139
v_and_b32 v31, s50, v139
v_mfma_f32_32x32x16_bf16 v[224:239], v[52:55], v[44:47], v[224:239]
v_fma_f32 v24, v24, v18, v20
v_mfma_f32_32x32x16_bf16 v[192:207], v[56:59], v[40:43], v[192:207]
v_fma_f32 v25, v25, v18, v20
v_mfma_f32_32x32x16_bf16 v[240:255], v[56:59], v[44:47], v[240:255]
v_fma_f32 v26, v26, v18, v20
v_fma_f32 v27, v27, v18, v20
v_mfma_f32_32x32x16_bf16 v[160:175], v[68:71], v[60:63], v[160:175]
v_fma_f32 v28, v28, v18, v20
v_mfma_f32_32x32x16_bf16 v[208:223], v[68:71], v[64:67], v[208:223]
v_fma_f32 v29, v29, v18, v20
v_mfma_f32_32x32x16_bf16 v[176:191], v[72:75], v[60:63], v[176:191]
v_fma_f32 v30, v30, v18, v20
v_fma_f32 v31, v31, v18, v20
v_mfma_f32_32x32x16_bf16 v[224:239], v[72:75], v[64:67], v[224:239]
v_cvt_pk_bf16_f32 v32, v24, v25
v_mfma_f32_32x32x16_bf16 v[192:207], v[76:79], v[60:63], v[192:207]
v_cvt_pk_bf16_f32 v33, v26, v27
v_mfma_f32_32x32x16_bf16 v[240:255], v[76:79], v[64:67], v[240:255]
v_cvt_pk_bf16_f32 v34, v28, v29
v_cvt_pk_bf16_f32 v35, v30, v31
s_setprio 0
s_barrier
ds_read_b128 v[40:43], v10 offset:0
ds_read_b128 v[44:47], v10 offset:4096
ds_read_b64_tr_b16 v[48:49], v7 offset:0
ds_read_b64_tr_b16 v[50:51], v7 offset:1536
ds_read_b64_tr_b16 v[52:53], v7 offset:512
ds_read_b64_tr_b16 v[54:55], v7 offset:2048
ds_read_b64_tr_b16 v[56:57], v7 offset:1024
ds_read_b64_tr_b16 v[58:59], v7 offset:2560
ds_read_b128 v[60:63], v11 offset:0
ds_read_b128 v[64:67], v11 offset:4096
ds_read_b64_tr_b16 v[68:69], v7 offset:6144
ds_read_b64_tr_b16 v[70:71], v7 offset:7680
ds_read_b64_tr_b16 v[72:73], v7 offset:6656
ds_read_b64_tr_b16 v[74:75], v7 offset:8192
ds_read_b64_tr_b16 v[76:77], v7 offset:7168
ds_read_b64_tr_b16 v[78:79], v7 offset:8704
ds_write_b128 v14, v[32:35] offset:16384
s_add_u32 m0, s44, 24832
s_nop 0
buffer_load_dwordx4 v2, s[12:15], s80 offen lds
s_add_u32 m0, s44, 25856
s_nop 0
buffer_load_dwordx4 v3, s[12:15], s80 offen lds
s_add_u32 m0, s44, 26880
s_nop 0
buffer_load_dwordx4 v4, s[12:15], s80 offen lds
s_waitcnt vmcnt(9) lgkmcnt(0)
s_barrier
s_setprio 1
.p2align 3
v_mfma_f32_32x32x16_bf16 v[160:175], v[48:51], v[40:43], v[160:175]
v_lshlrev_b32 v24, 16, v140
v_and_b32 v25, s50, v140
v_mfma_f32_32x32x16_bf16 v[208:223], v[48:51], v[44:47], v[208:223]
v_lshlrev_b32 v26, 16, v141
v_and_b32 v27, s50, v141
v_mfma_f32_32x32x16_bf16 v[176:191], v[52:55], v[40:43], v[176:191]
v_lshlrev_b32 v28, 16, v142
v_and_b32 v29, s50, v142
v_lshlrev_b32 v30, 16, v143
v_and_b32 v31, s50, v143
v_mfma_f32_32x32x16_bf16 v[224:239], v[52:55], v[44:47], v[224:239]
v_fma_f32 v24, v24, v19, v23
v_mfma_f32_32x32x16_bf16 v[192:207], v[56:59], v[40:43], v[192:207]
v_fma_f32 v25, v25, v19, v23
v_mfma_f32_32x32x16_bf16 v[240:255], v[56:59], v[44:47], v[240:255]
v_fma_f32 v26, v26, v19, v23
v_fma_f32 v27, v27, v19, v23
v_mfma_f32_32x32x16_bf16 v[160:175], v[68:71], v[60:63], v[160:175]
v_fma_f32 v28, v28, v19, v23
v_mfma_f32_32x32x16_bf16 v[208:223], v[68:71], v[64:67], v[208:223]
v_fma_f32 v29, v29, v19, v23
v_mfma_f32_32x32x16_bf16 v[176:191], v[72:75], v[60:63], v[176:191]
v_fma_f32 v30, v30, v19, v23
v_fma_f32 v31, v31, v19, v23
v_mfma_f32_32x32x16_bf16 v[224:239], v[72:75], v[64:67], v[224:239]
v_cvt_pk_bf16_f32 v36, v24, v25
v_mfma_f32_32x32x16_bf16 v[192:207], v[76:79], v[60:63], v[192:207]
v_cvt_pk_bf16_f32 v37, v26, v27
v_mfma_f32_32x32x16_bf16 v[240:255], v[76:79], v[64:67], v[240:255]
v_cvt_pk_bf16_f32 v38, v28, v29
v_cvt_pk_bf16_f32 v39, v30, v31
s_setprio 0
s_barrier
ds_read_b128 v[40:43], v12 offset:0
ds_read_b128 v[44:47], v12 offset:4096
ds_read_b64_tr_b16 v[48:49], v7 offset:24832
ds_read_b64_tr_b16 v[50:51], v7 offset:26368
ds_read_b64_tr_b16 v[52:53], v7 offset:25344
ds_read_b64_tr_b16 v[54:55], v7 offset:26880
ds_read_b64_tr_b16 v[56:57], v7 offset:25856
ds_read_b64_tr_b16 v[58:59], v7 offset:27392
ds_read_b128 v[60:63], v13 offset:0
ds_read_b128 v[64:67], v13 offset:4096
ds_read_b64_tr_b16 v[68:69], v7 offset:30976
ds_read_b64_tr_b16 v[70:71], v7 offset:32512
ds_read_b64_tr_b16 v[72:73], v7 offset:31488
ds_read_b64_tr_b16 v[74:75], v7 offset:33024
ds_read_b64_tr_b16 v[76:77], v7 offset:32000
ds_read_b64_tr_b16 v[78:79], v7 offset:33536
ds_write_b128 v15, v[36:39] offset:16384
s_add_u32 m0, s44, 49664
s_nop 0
buffer_load_dwordx4 v2, s[12:15], s81 offen lds
s_add_u32 m0, s44, 50688
s_nop 0
buffer_load_dwordx4 v3, s[12:15], s81 offen lds
s_add_u32 m0, s44, 51712
s_nop 0
buffer_load_dwordx4 v4, s[12:15], s81 offen lds
s_waitcnt vmcnt(9) lgkmcnt(0)
s_barrier
s_setprio 1
.p2align 3
v_mfma_f32_32x32x16_bf16 v[160:175], v[48:51], v[40:43], v[160:175]
v_lshlrev_b32 v24, 16, v144
v_and_b32 v25, s50, v144
v_mfma_f32_32x32x16_bf16 v[208:223], v[48:51], v[44:47], v[208:223]
v_lshlrev_b32 v26, 16, v145
v_and_b32 v27, s50, v145
v_mfma_f32_32x32x16_bf16 v[176:191], v[52:55], v[40:43], v[176:191]
v_lshlrev_b32 v28, 16, v146
v_and_b32 v29, s50, v146
v_lshlrev_b32 v30, 16, v147
v_and_b32 v31, s50, v147
v_mfma_f32_32x32x16_bf16 v[224:239], v[52:55], v[44:47], v[224:239]
v_fma_f32 v24, v24, v18, v20
v_mfma_f32_32x32x16_bf16 v[192:207], v[56:59], v[40:43], v[192:207]
v_fma_f32 v25, v25, v18, v20
v_mfma_f32_32x32x16_bf16 v[240:255], v[56:59], v[44:47], v[240:255]
v_fma_f32 v26, v26, v18, v20
v_fma_f32 v27, v27, v18, v20
v_mfma_f32_32x32x16_bf16 v[160:175], v[68:71], v[60:63], v[160:175]
v_fma_f32 v28, v28, v18, v20
v_mfma_f32_32x32x16_bf16 v[208:223], v[68:71], v[64:67], v[208:223]
v_fma_f32 v29, v29, v18, v20
v_mfma_f32_32x32x16_bf16 v[176:191], v[72:75], v[60:63], v[176:191]
v_fma_f32 v30, v30, v18, v20
v_fma_f32 v31, v31, v18, v20
v_mfma_f32_32x32x16_bf16 v[224:239], v[72:75], v[64:67], v[224:239]
v_cvt_pk_bf16_f32 v32, v24, v25
v_mfma_f32_32x32x16_bf16 v[192:207], v[76:79], v[60:63], v[192:207]
v_cvt_pk_bf16_f32 v33, v26, v27
v_mfma_f32_32x32x16_bf16 v[240:255], v[76:79], v[64:67], v[240:255]
v_cvt_pk_bf16_f32 v34, v28, v29
v_cvt_pk_bf16_f32 v35, v30, v31
s_setprio 0
s_barrier
ds_read_b128 v[40:43], v10 offset:16384
ds_read_b128 v[44:47], v10 offset:20480
ds_read_b64_tr_b16 v[48:49], v8 offset:0
ds_read_b64_tr_b16 v[50:51], v8 offset:1536
ds_read_b64_tr_b16 v[52:53], v8 offset:512
ds_read_b64_tr_b16 v[54:55], v8 offset:2048
ds_read_b64_tr_b16 v[56:57], v8 offset:1024
ds_read_b64_tr_b16 v[58:59], v8 offset:2560
ds_read_b128 v[60:63], v11 offset:16384
ds_read_b128 v[64:67], v11 offset:20480
ds_read_b64_tr_b16 v[68:69], v8 offset:6144
ds_read_b64_tr_b16 v[70:71], v8 offset:7680
ds_read_b64_tr_b16 v[72:73], v8 offset:6656
ds_read_b64_tr_b16 v[74:75], v8 offset:8192
ds_read_b64_tr_b16 v[76:77], v8 offset:7168
ds_read_b64_tr_b16 v[78:79], v8 offset:8704
ds_write_b128 v14, v[32:35] offset:0
s_add_u32 m0, s44, 74496
s_nop 0
buffer_load_dwordx4 v2, s[12:15], s82 offen lds
s_add_u32 m0, s44, 75520
s_nop 0
buffer_load_dwordx4 v3, s[12:15], s82 offen lds
s_add_u32 m0, s44, 76544
s_nop 0
buffer_load_dwordx4 v4, s[12:15], s82 offen lds
s_waitcnt vmcnt(9) lgkmcnt(0)
s_barrier
s_setprio 1
.p2align 3
v_mfma_f32_32x32x16_bf16 v[160:175], v[48:51], v[40:43], v[160:175]
v_lshlrev_b32 v24, 16, v148
v_and_b32 v25, s50, v148
v_mfma_f32_32x32x16_bf16 v[208:223], v[48:51], v[44:47], v[208:223]
v_lshlrev_b32 v26, 16, v149
v_and_b32 v27, s50, v149
v_mfma_f32_32x32x16_bf16 v[176:191], v[52:55], v[40:43], v[176:191]
v_lshlrev_b32 v28, 16, v150
v_and_b32 v29, s50, v150
v_lshlrev_b32 v30, 16, v151
v_and_b32 v31, s50, v151
v_mfma_f32_32x32x16_bf16 v[224:239], v[52:55], v[44:47], v[224:239]
v_fma_f32 v24, v24, v19, v23
v_mfma_f32_32x32x16_bf16 v[192:207], v[56:59], v[40:43], v[192:207]
v_fma_f32 v25, v25, v19, v23
v_mfma_f32_32x32x16_bf16 v[240:255], v[56:59], v[44:47], v[240:255]
v_fma_f32 v26, v26, v19, v23
v_fma_f32 v27, v27, v19, v23
v_mfma_f32_32x32x16_bf16 v[160:175], v[68:71], v[60:63], v[160:175]
v_fma_f32 v28, v28, v19, v23
v_mfma_f32_32x32x16_bf16 v[208:223], v[68:71], v[64:67], v[208:223]
v_fma_f32 v29, v29, v19, v23
v_mfma_f32_32x32x16_bf16 v[176:191], v[72:75], v[60:63], v[176:191]
v_fma_f32 v30, v30, v19, v23
v_fma_f32 v31, v31, v19, v23
v_mfma_f32_32x32x16_bf16 v[224:239], v[72:75], v[64:67], v[224:239]
v_cvt_pk_bf16_f32 v36, v24, v25
v_mfma_f32_32x32x16_bf16 v[192:207], v[76:79], v[60:63], v[192:207]
v_cvt_pk_bf16_f32 v37, v26, v27
v_mfma_f32_32x32x16_bf16 v[240:255], v[76:79], v[64:67], v[240:255]
v_cvt_pk_bf16_f32 v38, v28, v29
v_cvt_pk_bf16_f32 v39, v30, v31
s_setprio 0
s_barrier
ds_read_b128 v[40:43], v12 offset:16384
ds_read_b128 v[44:47], v12 offset:20480
ds_read_b64_tr_b16 v[48:49], v6 offset:0
ds_read_b64_tr_b16 v[50:51], v6 offset:1536
ds_read_b64_tr_b16 v[52:53], v6 offset:512
ds_read_b64_tr_b16 v[54:55], v6 offset:2048
ds_read_b64_tr_b16 v[56:57], v6 offset:1024
ds_read_b64_tr_b16 v[58:59], v6 offset:2560
ds_read_b128 v[60:63], v13 offset:16384
ds_read_b128 v[64:67], v13 offset:20480
ds_read_b64_tr_b16 v[68:69], v6 offset:6144
ds_read_b64_tr_b16 v[70:71], v6 offset:7680
ds_read_b64_tr_b16 v[72:73], v6 offset:6656
ds_read_b64_tr_b16 v[74:75], v6 offset:8192
ds_read_b64_tr_b16 v[76:77], v6 offset:7168
ds_read_b64_tr_b16 v[78:79], v6 offset:8704
ds_write_b128 v15, v[36:39] offset:0
s_add_u32 m0, s44, 99328
s_nop 0
buffer_load_dwordx4 v2, s[12:15], s83 offen lds
s_add_u32 m0, s44, 100352
s_nop 0
buffer_load_dwordx4 v3, s[12:15], s83 offen lds
s_add_u32 m0, s44, 101376
s_nop 0
buffer_load_dwordx4 v4, s[12:15], s83 offen lds
s_waitcnt vmcnt(9) lgkmcnt(0)
s_barrier
s_setprio 1
.p2align 3
v_mfma_f32_32x32x16_bf16 v[160:175], v[48:51], v[40:43], v[160:175]
v_lshlrev_b32 v24, 16, v152
v_and_b32 v25, s50, v152
v_mfma_f32_32x32x16_bf16 v[208:223], v[48:51], v[44:47], v[208:223]
v_lshlrev_b32 v26, 16, v153
v_and_b32 v27, s50, v153
v_mfma_f32_32x32x16_bf16 v[176:191], v[52:55], v[40:43], v[176:191]
v_lshlrev_b32 v28, 16, v154
v_and_b32 v29, s50, v154
v_lshlrev_b32 v30, 16, v155
v_and_b32 v31, s50, v155
v_mfma_f32_32x32x16_bf16 v[224:239], v[52:55], v[44:47], v[224:239]
v_fma_f32 v24, v24, v18, v20
v_mfma_f32_32x32x16_bf16 v[192:207], v[56:59], v[40:43], v[192:207]
v_fma_f32 v25, v25, v18, v20
v_mfma_f32_32x32x16_bf16 v[240:255], v[56:59], v[44:47], v[240:255]
v_fma_f32 v26, v26, v18, v20
v_fma_f32 v27, v27, v18, v20
v_mfma_f32_32x32x16_bf16 v[160:175], v[68:71], v[60:63], v[160:175]
v_fma_f32 v28, v28, v18, v20
v_mfma_f32_32x32x16_bf16 v[208:223], v[68:71], v[64:67], v[208:223]
v_fma_f32 v29, v29, v18, v20
v_mfma_f32_32x32x16_bf16 v[176:191], v[72:75], v[60:63], v[176:191]
v_fma_f32 v30, v30, v18, v20
v_fma_f32 v31, v31, v18, v20
v_mfma_f32_32x32x16_bf16 v[224:239], v[72:75], v[64:67], v[224:239]
v_cvt_pk_bf16_f32 v32, v24, v25
v_mfma_f32_32x32x16_bf16 v[192:207], v[76:79], v[60:63], v[192:207]
v_cvt_pk_bf16_f32 v33, v26, v27
v_mfma_f32_32x32x16_bf16 v[240:255], v[76:79], v[64:67], v[240:255]
v_cvt_pk_bf16_f32 v34, v28, v29
v_cvt_pk_bf16_f32 v35, v30, v31
s_setprio 0
s_barrier
ds_read_b128 v[40:43], v10 offset:0
ds_read_b128 v[44:47], v10 offset:4096
ds_read_b64_tr_b16 v[48:49], v6 offset:24832
ds_read_b64_tr_b16 v[50:51], v6 offset:26368
ds_read_b64_tr_b16 v[52:53], v6 offset:25344
ds_read_b64_tr_b16 v[54:55], v6 offset:26880
ds_read_b64_tr_b16 v[56:57], v6 offset:25856
ds_read_b64_tr_b16 v[58:59], v6 offset:27392
ds_read_b128 v[60:63], v11 offset:0
ds_read_b128 v[64:67], v11 offset:4096
ds_read_b64_tr_b16 v[68:69], v6 offset:30976
ds_read_b64_tr_b16 v[70:71], v6 offset:32512
ds_read_b64_tr_b16 v[72:73], v6 offset:31488
ds_read_b64_tr_b16 v[74:75], v6 offset:33024
ds_read_b64_tr_b16 v[76:77], v6 offset:32000
ds_read_b64_tr_b16 v[78:79], v6 offset:33536
ds_write_b128 v14, v[32:35] offset:16384
s_waitcnt vmcnt(6) lgkmcnt(0)
s_barrier
s_setprio 1
.p2align 3
v_mfma_f32_32x32x16_bf16 v[160:175], v[48:51], v[40:43], v[160:175]
v_lshlrev_b32 v24, 16, v156
v_and_b32 v25, s50, v156
v_mfma_f32_32x32x16_bf16 v[208:223], v[48:51], v[44:47], v[208:223]
v_lshlrev_b32 v26, 16, v157
v_and_b32 v27, s50, v157
v_mfma_f32_32x32x16_bf16 v[176:191], v[52:55], v[40:43], v[176:191]
v_lshlrev_b32 v28, 16, v158
v_and_b32 v29, s50, v158
v_lshlrev_b32 v30, 16, v159
v_and_b32 v31, s50, v159
v_mfma_f32_32x32x16_bf16 v[224:239], v[52:55], v[44:47], v[224:239]
v_fma_f32 v24, v24, v19, v23
v_mfma_f32_32x32x16_bf16 v[192:207], v[56:59], v[40:43], v[192:207]
v_fma_f32 v25, v25, v19, v23
v_mfma_f32_32x32x16_bf16 v[240:255], v[56:59], v[44:47], v[240:255]
v_fma_f32 v26, v26, v19, v23
v_fma_f32 v27, v27, v19, v23
v_mfma_f32_32x32x16_bf16 v[160:175], v[68:71], v[60:63], v[160:175]
v_fma_f32 v28, v28, v19, v23
v_mfma_f32_32x32x16_bf16 v[208:223], v[68:71], v[64:67], v[208:223]
v_fma_f32 v29, v29, v19, v23
v_mfma_f32_32x32x16_bf16 v[176:191], v[72:75], v[60:63], v[176:191]
v_fma_f32 v30, v30, v19, v23
v_fma_f32 v31, v31, v19, v23
v_mfma_f32_32x32x16_bf16 v[224:239], v[72:75], v[64:67], v[224:239]
v_cvt_pk_bf16_f32 v36, v24, v25
v_mfma_f32_32x32x16_bf16 v[192:207], v[76:79], v[60:63], v[192:207]
v_cvt_pk_bf16_f32 v37, v26, v27
v_mfma_f32_32x32x16_bf16 v[240:255], v[76:79], v[64:67], v[240:255]
v_cvt_pk_bf16_f32 v38, v28, v29
v_cvt_pk_bf16_f32 v39, v30, v31
s_setprio 0
s_barrier
ds_read_b128 v[40:43], v12 offset:0
ds_read_b128 v[44:47], v12 offset:4096
ds_read_b64_tr_b16 v[48:49], v7 offset:0
ds_read_b64_tr_b16 v[50:51], v7 offset:1536
ds_read_b64_tr_b16 v[52:53], v7 offset:512
ds_read_b64_tr_b16 v[54:55], v7 offset:2048
ds_read_b64_tr_b16 v[56:57], v7 offset:1024
ds_read_b64_tr_b16 v[58:59], v7 offset:2560
ds_read_b128 v[60:63], v13 offset:0
ds_read_b128 v[64:67], v13 offset:4096
ds_read_b64_tr_b16 v[68:69], v7 offset:6144
ds_read_b64_tr_b16 v[70:71], v7 offset:7680
ds_read_b64_tr_b16 v[72:73], v7 offset:6656
ds_read_b64_tr_b16 v[74:75], v7 offset:8192
ds_read_b64_tr_b16 v[76:77], v7 offset:7168
ds_read_b64_tr_b16 v[78:79], v7 offset:8704
ds_write_b128 v15, v[36:39] offset:16384
s_waitcnt vmcnt(3) lgkmcnt(0)
s_barrier
s_setprio 1
.p2align 3
v_mfma_f32_32x32x16_bf16 v[160:175], v[48:51], v[40:43], v[160:175]
v_mfma_f32_32x32x16_bf16 v[208:223], v[48:51], v[44:47], v[208:223]
v_mfma_f32_32x32x16_bf16 v[176:191], v[52:55], v[40:43], v[176:191]
v_mfma_f32_32x32x16_bf16 v[224:239], v[52:55], v[44:47], v[224:239]
v_mfma_f32_32x32x16_bf16 v[192:207], v[56:59], v[40:43], v[192:207]
v_mfma_f32_32x32x16_bf16 v[240:255], v[56:59], v[44:47], v[240:255]
v_mfma_f32_32x32x16_bf16 v[160:175], v[68:71], v[60:63], v[160:175]
v_mfma_f32_32x32x16_bf16 v[208:223], v[68:71], v[64:67], v[208:223]
v_mfma_f32_32x32x16_bf16 v[176:191], v[72:75], v[60:63], v[176:191]
v_mfma_f32_32x32x16_bf16 v[224:239], v[72:75], v[64:67], v[224:239]
v_mfma_f32_32x32x16_bf16 v[192:207], v[76:79], v[60:63], v[192:207]
v_mfma_f32_32x32x16_bf16 v[240:255], v[76:79], v[64:67], v[240:255]
s_setprio 0
s_barrier
ds_read_b128 v[40:43], v10 offset:16384
ds_read_b128 v[44:47], v10 offset:20480
ds_read_b64_tr_b16 v[48:49], v7 offset:24832
ds_read_b64_tr_b16 v[50:51], v7 offset:26368
ds_read_b64_tr_b16 v[52:53], v7 offset:25344
ds_read_b64_tr_b16 v[54:55], v7 offset:26880
ds_read_b64_tr_b16 v[56:57], v7 offset:25856
ds_read_b64_tr_b16 v[58:59], v7 offset:27392
ds_read_b128 v[60:63], v11 offset:16384
ds_read_b128 v[64:67], v11 offset:20480
ds_read_b64_tr_b16 v[68:69], v7 offset:30976
ds_read_b64_tr_b16 v[70:71], v7 offset:32512
ds_read_b64_tr_b16 v[72:73], v7 offset:31488
ds_read_b64_tr_b16 v[74:75], v7 offset:33024
ds_read_b64_tr_b16 v[76:77], v7 offset:32000
ds_read_b64_tr_b16 v[78:79], v7 offset:33536
s_waitcnt vmcnt(0) lgkmcnt(0)
s_barrier
s_setprio 1
.p2align 3
v_mfma_f32_32x32x16_bf16 v[160:175], v[48:51], v[40:43], v[160:175]
v_mfma_f32_32x32x16_bf16 v[208:223], v[48:51], v[44:47], v[208:223]
v_mfma_f32_32x32x16_bf16 v[176:191], v[52:55], v[40:43], v[176:191]
v_mfma_f32_32x32x16_bf16 v[224:239], v[52:55], v[44:47], v[224:239]
v_mfma_f32_32x32x16_bf16 v[192:207], v[56:59], v[40:43], v[192:207]
v_mfma_f32_32x32x16_bf16 v[240:255], v[56:59], v[44:47], v[240:255]
v_mfma_f32_32x32x16_bf16 v[160:175], v[68:71], v[60:63], v[160:175]
v_mfma_f32_32x32x16_bf16 v[208:223], v[68:71], v[64:67], v[208:223]
v_mfma_f32_32x32x16_bf16 v[176:191], v[72:75], v[60:63], v[176:191]
v_mfma_f32_32x32x16_bf16 v[224:239], v[72:75], v[64:67], v[224:239]
v_mfma_f32_32x32x16_bf16 v[192:207], v[76:79], v[60:63], v[192:207]
v_mfma_f32_32x32x16_bf16 v[240:255], v[76:79], v[64:67], v[240:255]
s_setprio 0
s_barrier
ds_read_b128 v[40:43], v12 offset:16384
ds_read_b128 v[44:47], v12 offset:20480
ds_read_b64_tr_b16 v[48:49], v8 offset:0
ds_read_b64_tr_b16 v[50:51], v8 offset:1536
ds_read_b64_tr_b16 v[52:53], v8 offset:512
ds_read_b64_tr_b16 v[54:55], v8 offset:2048
ds_read_b64_tr_b16 v[56:57], v8 offset:1024
ds_read_b64_tr_b16 v[58:59], v8 offset:2560
ds_read_b128 v[60:63], v13 offset:16384
ds_read_b128 v[64:67], v13 offset:20480
ds_read_b64_tr_b16 v[68:69], v8 offset:6144
ds_read_b64_tr_b16 v[70:71], v8 offset:7680
ds_read_b64_tr_b16 v[72:73], v8 offset:6656
ds_read_b64_tr_b16 v[74:75], v8 offset:8192
ds_read_b64_tr_b16 v[76:77], v8 offset:7168
ds_read_b64_tr_b16 v[78:79], v8 offset:8704
s_waitcnt lgkmcnt(0)
s_barrier
s_setprio 1
.p2align 3
v_mfma_f32_32x32x16_bf16 v[160:175], v[48:51], v[40:43], v[160:175]
v_mfma_f32_32x32x16_bf16 v[208:223], v[48:51], v[44:47], v[208:223]
v_mfma_f32_32x32x16_bf16 v[176:191], v[52:55], v[40:43], v[176:191]
v_mfma_f32_32x32x16_bf16 v[224:239], v[52:55], v[44:47], v[224:239]
v_mfma_f32_32x32x16_bf16 v[192:207], v[56:59], v[40:43], v[192:207]
v_mfma_f32_32x32x16_bf16 v[240:255], v[56:59], v[44:47], v[240:255]
v_mfma_f32_32x32x16_bf16 v[160:175], v[68:71], v[60:63], v[160:175]
v_mfma_f32_32x32x16_bf16 v[208:223], v[68:71], v[64:67], v[208:223]
v_mfma_f32_32x32x16_bf16 v[176:191], v[72:75], v[60:63], v[176:191]
v_mfma_f32_32x32x16_bf16 v[224:239], v[72:75], v[64:67], v[224:239]
v_mfma_f32_32x32x16_bf16 v[192:207], v[76:79], v[60:63], v[192:207]
v_mfma_f32_32x32x16_bf16 v[240:255], v[76:79], v[64:67], v[240:255]
s_setprio 0
s_cmp_eq_u32 s54, 0
s_cbranch_scc0 L_g1_2
s_barrier
L_g1_2:
v_bfe_u32 v17, v1, 4, 1
v_lshlrev_b32 v17, 10, v17
v_lshrrev_b32 v40, 5, v1
v_lshl_add_u32 v17, v40, 8, v17
v_and_b32 v40, 15, v1
v_lshl_add_u32 v17, v40, 4, v17
s_lshl_b32 s45, s37, 1
s_add_u32 s45, s45, s54
s_mul_i32 s45, s45, 48
s_mul_i32 s49, s38, 6
s_add_u32 s45, s45, s49
s_lshr_b32 s49, s55, 1
s_add_u32 s45, s45, s49
s_lshl_b32 s45, s45, 12
s_and_b32 s49, s55, 1
s_lshl_b32 s49, s49, 9
s_add_u32 s45, s45, s49
s_nop 7
s_nop 3
v_mul_f32 v160, v160, v168
v_mul_f32 v161, v161, v169
v_mul_f32 v162, v162, v170
v_mul_f32 v163, v163, v171
v_mul_f32 v164, v164, v172
v_mul_f32 v165, v165, v173
v_mul_f32 v166, v166, v174
v_mul_f32 v167, v167, v175
v_cvt_pk_bf16_f32 v24, v160, v161
v_cvt_pk_bf16_f32 v25, v162, v163
v_cvt_pk_bf16_f32 v26, v164, v165
v_cvt_pk_bf16_f32 v27, v166, v167
s_add_u32 s49, s45, 0
buffer_store_dwordx4 v[24:27], v17, s[16:19], s49 offen sc0 sc1
v_mul_f32 v176, v176, v184
v_mul_f32 v177, v177, v185
v_mul_f32 v178, v178, v186
v_mul_f32 v179, v179, v187
v_mul_f32 v180, v180, v188
v_mul_f32 v181, v181, v189
v_mul_f32 v182, v182, v190
v_mul_f32 v183, v183, v191
v_cvt_pk_bf16_f32 v28, v176, v177
v_cvt_pk_bf16_f32 v29, v178, v179
v_cvt_pk_bf16_f32 v30, v180, v181
v_cvt_pk_bf16_f32 v31, v182, v183
s_add_u32 s49, s45, 8192
buffer_store_dwordx4 v[28:31], v17, s[16:19], s49 offen sc0 sc1
v_mul_f32 v192, v192, v200
v_mul_f32 v193, v193, v201
v_mul_f32 v194, v194, v202
v_mul_f32 v195, v195, v203
v_mul_f32 v196, v196, v204
v_mul_f32 v197, v197, v205
v_mul_f32 v198, v198, v206
v_mul_f32 v199, v199, v207
v_cvt_pk_bf16_f32 v32, v192, v193
v_cvt_pk_bf16_f32 v33, v194, v195
v_cvt_pk_bf16_f32 v34, v196, v197
v_cvt_pk_bf16_f32 v35, v198, v199
s_add_u32 s49, s45, 16384
buffer_store_dwordx4 v[32:35], v17, s[16:19], s49 offen sc0 sc1
v_mul_f32 v208, v208, v216
v_mul_f32 v209, v209, v217
v_mul_f32 v210, v210, v218
v_mul_f32 v211, v211, v219
v_mul_f32 v212, v212, v220
v_mul_f32 v213, v213, v221
v_mul_f32 v214, v214, v222
v_mul_f32 v215, v215, v223
v_cvt_pk_bf16_f32 v36, v208, v209
v_cvt_pk_bf16_f32 v37, v210, v211
v_cvt_pk_bf16_f32 v38, v212, v213
v_cvt_pk_bf16_f32 v39, v214, v215
s_add_u32 s49, s45, 2048
buffer_store_dwordx4 v[36:39], v17, s[16:19], s49 offen sc0 sc1
v_mul_f32 v224, v224, v232
v_mul_f32 v225, v225, v233
v_mul_f32 v226, v226, v234
v_mul_f32 v227, v227, v235
v_mul_f32 v228, v228, v236
v_mul_f32 v229, v229, v237
v_mul_f32 v230, v230, v238
v_mul_f32 v231, v231, v239
v_cvt_pk_bf16_f32 v24, v224, v225
v_cvt_pk_bf16_f32 v25, v226, v227
v_cvt_pk_bf16_f32 v26, v228, v229
v_cvt_pk_bf16_f32 v27, v230, v231
s_add_u32 s49, s45, 10240
buffer_store_dwordx4 v[24:27], v17, s[16:19], s49 offen sc0 sc1
v_mul_f32 v240, v240, v248
v_mul_f32 v241, v241, v249
v_mul_f32 v242, v242, v250
v_mul_f32 v243, v243, v251
v_mul_f32 v244, v244, v252
v_mul_f32 v245, v245, v253
v_mul_f32 v246, v246, v254
v_mul_f32 v247, v247, v255
v_cvt_pk_bf16_f32 v28, v240, v241
v_cvt_pk_bf16_f32 v29, v242, v243
v_cvt_pk_bf16_f32 v30, v244, v245
v_cvt_pk_bf16_f32 v31, v246, v247
s_add_u32 s49, s45, 18432
buffer_store_dwordx4 v[28:31], v17, s[16:19], s49 offen sc0 sc1
s_or_b32 s45, s2, s36
s_cmp_eq_u32 s45, 0
s_cbranch_scc0 L_zf_3
v_mov_b32 v40, 0
v_mov_b32 v41, 0
v_mov_b32 v42, 0
v_mov_b32 v43, 0
v_lshlrev_b32 v44, 4, v1
s_mov_b32 s49, 20250624
buffer_store_dwordx4 v[40:43], v44, s[16:19], s49 offen sc0 sc1
L_zf_3:
s_endpgm
L_k1_A:
s_mul_i32 s53, s37, 163840
s_lshl_b32 s57, s39, 7
s_add_u32 s52, s53, s57
buffer_load_dwordx4 v[80:83], v38, s[8:11], s52 offen
buffer_load_dwordx4 v[84:87], v39, s[8:11], s52 offen
s_add_u32 s57, s57, 128
s_cmp_eq_u32 s57, 1280
s_cselect_b32 s57, 0, s57
s_add_u32 s52, s53, s57
buffer_load_dwordx4 v[88:91], v38, s[8:11], s52 offen
buffer_load_dwordx4 v[92:95], v39, s[8:11], s52 offen
s_add_u32 s57, s57, 128
s_cmp_eq_u32 s57, 1280
s_cselect_b32 s57, 0, s57
v_mov_b32 v40, 0
v_mov_b32 v41, 0
v_mov_b32 v42, 0
v_mov_b32 v43, 0
v_mov_b32 v44, 0
v_mov_b32 v45, 0
v_mov_b32 v46, 0
v_mov_b32 v47, 0
s_waitcnt vmcnt(0)
s_add_u32 s52, s53, s57
buffer_load_dwordx4 v[96:99], v38, s[8:11], s52 offen
buffer_load_dwordx4 v[100:103], v39, s[8:11], s52 offen
s_add_u32 s57, s57, 128
s_cmp_eq_u32 s57, 1280
s_cselect_b32 s57, 0, s57
s_add_u32 s52, s53, s57
buffer_load_dwordx4 v[104:107], v38, s[8:11], s52 offen
buffer_load_dwordx4 v[108:111], v39, s[8:11], s52 offen
s_add_u32 s57, s57, 128
s_cmp_eq_u32 s57, 1280
s_cselect_b32 s57, 0, s57
s_add_u32 s52, s53, s57
buffer_load_dwordx4 v[112:115], v38, s[8:11], s52 offen
buffer_load_dwordx4 v[116:119], v39, s[8:11], s52 offen
s_add_u32 s57, s57, 128
s_cmp_eq_u32 s57, 1280
s_cselect_b32 s57, 0, s57
s_add_u32 s52, s53, s57
buffer_load_dwordx4 v[120:123], v38, s[8:11], s52 offen
buffer_load_dwordx4 v[124:127], v39, s[8:11], s52 offen
s_add_u32 s57, s57, 128
s_cmp_eq_u32 s57, 1280
s_cselect_b32 s57, 0, s57
s_add_u32 s52, s53, s57
buffer_load_dwordx4 v[128:131], v38, s[8:11], s52 offen
buffer_load_dwordx4 v[132:135], v39, s[8:11], s52 offen
s_add_u32 s57, s57, 128
s_cmp_eq_u32 s57, 1280
s_cselect_b32 s57, 0, s57
s_add_u32 s52, s53, s57
buffer_load_dwordx4 v[136:139], v38, s[8:11], s52 offen
buffer_load_dwordx4 v[140:143], v39, s[8:11], s52 offen
s_add_u32 s57, s57, 128
s_cmp_eq_u32 s57, 1280
s_cselect_b32 s57, 0, s57
s_add_u32 s52, s53, s57
buffer_load_dwordx4 v[144:147], v38, s[8:11], s52 offen
buffer_load_dwordx4 v[148:151], v39, s[8:11], s52 offen
s_add_u32 s57, s57, 128
s_cmp_eq_u32 s57, 1280
s_cselect_b32 s57, 0, s57
s_add_u32 s52, s53, s57
buffer_load_dwordx4 v[152:155], v38, s[8:11], s52 offen
buffer_load_dwordx4 v[156:159], v39, s[8:11], s52 offen
s_add_u32 s57, s57, 128
s_cmp_eq_u32 s57, 1280
s_cselect_b32 s57, 0, s57
s_mov_b32 s12, s6
s_and_b32 s13, s7, 0xffff
s_mov_b32 s14, 2457600
s_mov_b32 s15, 0x20000
s_mul_i32 s64, s39, 245760
s_add_u32 s65, s64, 245760
s_cmp_eq_u32 s65, 2457600
s_cselect_b32 s65, 0, s65
s_add_u32 s66, s65, 245760
s_cmp_eq_u32 s66, 2457600
s_cselect_b32 s66, 0, s66
s_mov_b32 s16, s34
s_and_b32 s17, s35, 0xffff
s_mov_b32 s18, 33554432
s_mov_b32 s19, 0x20000
v_and_b32 v17, 31, v1
v_lshrrev_b32 v24, 5, v1
v_bfe_u32 v25, v17, 1, 3
v_xor_b32 v25, v25, v24
v_lshlrev_b32 v25, 4, v25
s_lshl_b32 s45, s54, 13
v_lshl_add_u32 v25, v17, 7, v25
v_add_u32 v10, s45, v25
v_xor_b32 v11, 32, v10
v_xor_b32 v12, 64, v10
v_xor_b32 v13, 96, v10
v_lshrrev_b32 v30, 4, v1
v_and_b32 v27, 3, v1
v_lshl_add_u32 v30, v30, 2, v27
v_bfe_u32 v27, v1, 2, 2
s_lshl_b32 s45, s36, 2
v_add_u32 v27, s45, v27
v_mul_u32_u24 v27, 3840, v27
s_mul_i32 s49, s38, 160
v_add_u32 v27, s49, v27
v_cmp_gt_u32 vcc, 10, v30
v_mov_b32 v28, 1120
v_lshl_add_u32 v29, v30, 4, v27
v_cndmask_b32 v28, v28, 0, vcc
v_add_u32 v2, v29, v28
v_min_u32 v24, 14, v30
v_cmp_eq_u32 vcc, 4, v30
v_mov_b32 v25, 3
s_nop 0
v_cndmask_b32 v24, v24, v25, vcc
v_cmp_gt_u32 vcc, 5, v30
v_mov_b32 v25, 2480
v_mov_b32 v26, 1376
v_cndmask_b32 v25, v25, v26, vcc
v_lshl_add_u32 v24, v24, 4, v27
v_add_u32 v3, v24, v25
v_add_u32 v4, 122880, v2
v_add_u32 v5, 122880, v3
s_lshl_b32 s44, s36, 11
s_add_u32 s44, s44, 32768
v_and_b32 v24, 3, v1
v_bfe_u32 v25, v1, 4, 1
v_lshrrev_b32 v26, 1, v24
v_lshl_add_u32 v26, v25, 1, v26
v_and_b32 v27, 1, v24
s_mul_i32 s45, s55, 5
v_add_u32 v28, s45, v26
v_mul_u32_u24 v29, 10, v27
v_lshrrev_b32 v30, 1, v28
v_add_u32 v29, v29, v30
v_and_b32 v28, 1, v28
v_lshlrev_b32 v28, 3, v28
v_and_b32 v30, 3, v29
v_lshl_add_u32 v28, v30, 4, v28
v_lshrrev_b32 v29, 2, v29
v_lshl_add_u32 v28, v29, 8, v28
v_bfe_u32 v29, v1, 2, 2
v_lshl_add_u32 v28, v29, 6, v28
v_lshrrev_b32 v29, 5, v1
v_lshl_add_u32 v28, v29, 12, v28
v_add_u32 v6, 32768, v28
v_and_b32 v24, 3, v1
v_bfe_u32 v25, v1, 4, 1
v_lshrrev_b32 v26, 1, v24
v_lshl_add_u32 v26, v25, 1, v26
v_and_b32 v27, 1, v24
s_mul_i32 s45, s55, 5
v_mul_u32_u24 v28, 3, v27
v_add_u32 v28, v28, v26
v_subrev_u32 v28, 1, v28
v_min_u32 v28, 4, v28
v_mul_u32_u24 v29, 10, v27
v_cmp_eq_u32 vcc, 0, v26
v_mov_b32 v30, 21
s_nop 0
v_cndmask_b32 v28, v28, 4, vcc
v_cndmask_b32 v29, v30, v29, vcc
v_add_u32 v28, s45, v28
v_lshrrev_b32 v30, 1, v28
v_add_u32 v29, v29, v30
v_and_b32 v28, 1, v28
v_lshlrev_b32 v28, 3, v28
v_and_b32 v30, 3, v29
v_lshl_add_u32 v28, v30, 4, v28
v_lshrrev_b32 v29, 2, v29
v_lshl_add_u32 v28, v29, 8, v28
v_bfe_u32 v29, v1, 2, 2
v_lshl_add_u32 v28, v29, 6, v28
v_lshrrev_b32 v29, 5, v1
v_lshl_add_u32 v28, v29, 12, v28
v_add_u32 v8, 32768, v28
v_add_u32 v7, 65536, v6
v_add_u32 v9, 65536, v8
v_and_b32 v24, 3, v1
v_bfe_u32 v25, v1, 4, 1
v_lshrrev_b32 v26, 1, v24
v_lshl_add_u32 v26, v25, 1, v26
v_and_b32 v27, 1, v24
v_lshrrev_b32 v28, 5, v1
v_bfe_u32 v29, v1, 2, 2
v_mul_u32_u24 v29, 40, v29
v_lshl_add_u32 v29, v26, 3, v29
s_mul_i32 s45, s55, 800
s_add_u32 s45, s45, 131072
v_add_u32 v29, s45, v29
v_mov_b32 v30, 135168
v_cmp_eq_u32 vcc, v27, v28
s_nop 1
v_cndmask_b32 v72, v30, v29, vcc
v_cmp_eq_u32 vcc, 0, v26
s_nop 1
v_cndmask_b32 v73, v30, v72, vcc
v_and_b32 v24, 31, v1
v_bfe_u32 v25, v24, 1, 1
v_lshlrev_b32 v25, 2, v25
v_bfe_u32 v26, v24, 2, 1
v_lshl_or_b32 v25, v26, 1, v25
v_and_b32 v26, 1, v24
v_or_b32 v25, v25, v26
v_lshlrev_b32 v75, 4, v25
s_lshl_b32 s45, s55, 14
s_lshl_b32 s49, s54, 13
s_add_u32 s45, s45, s49
v_lshlrev_b32 v26, 7, v24
v_add_u32 v74, s45, v26
v_bfe_u32 v24, v1, 2, 2
v_lshrrev_b32 v25, 1, v24
v_lshlrev_b32 v25, 2, v25
v_and_b32 v26, 1, v24
v_or_b32 v25, v25, v26
v_lshrrev_b32 v26, 5, v1
v_lshl_add_u32 v26, v26, 3, v24
v_lshlrev_b32 v26, 7, v26
s_lshl_b32 s45, s55, 14
v_add_u32 v26, s45, v26
v_bfe_u32 v27, v1, 4, 1
v_and_b32 v28, 3, v1
v_lshl_add_u32 v27, v27, 2, v28
v_and_b32 v28, 4, v27
v_and_b32 v29, 1, v27
v_lshl_add_u32 v28, v29, 1, v28
v_bfe_u32 v29, v27, 1, 1
v_add_u32 v28, v28, v29
v_and_b32 v29, 1, v27
v_add_u32 v29, 8, v29
s_cmp_eq_u32 s54, 0
s_cselect_b64 vcc, -1, 0
v_cndmask_b32 v28, v29, v28, vcc
v_lshrrev_b32 v29, 1, v28
v_and_b32 v28, 1, v28
v_xor_b32 v30, v29, v25
v_lshlrev_b32 v30, 4, v30
v_lshl_add_u32 v30, v28, 3, v30
v_add_u32 v76, v26, v30
s_mov_b32 s49, 0xfffdceba
v_lshlrev_b32 v28, 2, v27
v_lshrrev_b32 v28, v28, s49
v_and_b32 v28, 15, v28
v_lshrrev_b32 v29, 1, v28
v_and_b32 v28, 1, v28
v_xor_b32 v30, v29, v25
v_lshlrev_b32 v30, 4, v30
v_lshl_add_u32 v30, v28, 3, v30
v_add_u32 v77, v26, v30
v_mov_b32 v160, 0
v_mov_b32 v161, 0
v_mov_b32 v162, 0
v_mov_b32 v163, 0
v_lshlrev_b32 v24, 4, v1
v_add_u32 v24, 135168, v24
ds_write_b128 v24, v[160:163]
v_dot2_f32_bf16 v40, v80, s51, v40
v_dot2_f32_bf16 v42, v80, v80, v42
v_dot2_f32_bf16 v41, v81, s51, v41
v_dot2_f32_bf16 v43, v81, v81, v43
v_dot2_f32_bf16 v40, v82, s51, v40
v_dot2_f32_bf16 v42, v82, v82, v42
v_dot2_f32_bf16 v41, v83, s51, v41
v_dot2_f32_bf16 v43, v83, v83, v43
v_dot2_f32_bf16 v44, v84, s51, v44
v_dot2_f32_bf16 v46, v84, v84, v46
v_dot2_f32_bf16 v45, v85, s51, v45
v_dot2_f32_bf16 v47, v85, v85, v47
v_dot2_f32_bf16 v44, v86, s51, v44
v_dot2_f32_bf16 v46, v86, v86, v46
v_dot2_f32_bf16 v45, v87, s51, v45
v_dot2_f32_bf16 v47, v87, v87, v47
v_dot2_f32_bf16 v40, v88, s51, v40
v_dot2_f32_bf16 v42, v88, v88, v42
v_dot2_f32_bf16 v41, v89, s51, v41
v_dot2_f32_bf16 v43, v89, v89, v43
v_dot2_f32_bf16 v40, v90, s51, v40
v_dot2_f32_bf16 v42, v90, v90, v42
v_dot2_f32_bf16 v41, v91, s51, v41
v_dot2_f32_bf16 v43, v91, v91, v43
v_dot2_f32_bf16 v44, v92, s51, v44
v_dot2_f32_bf16 v46, v92, v92, v46
v_dot2_f32_bf16 v45, v93, s51, v45
v_dot2_f32_bf16 v47, v93, v93, v47
v_dot2_f32_bf16 v44, v94, s51, v44
v_dot2_f32_bf16 v46, v94, v94, v46
v_dot2_f32_bf16 v45, v95, s51, v45
v_dot2_f32_bf16 v47, v95, v95, v47
s_add_u32 m0, s44, 0
s_nop 0
buffer_load_dwordx4 v2, s[12:15], s64 offen lds
s_add_u32 m0, s44, 1024
s_nop 0
buffer_load_dwordx4 v3, s[12:15], s64 offen lds
s_add_u32 m0, s44, 16384
s_nop 0
buffer_load_dwordx4 v4, s[12:15], s64 offen lds
s_add_u32 m0, s44, 17408
s_nop 0
buffer_load_dwordx4 v5, s[12:15], s64 offen lds
s_mov_b32 s20, s24
s_and_b32 s21, s25, 0xffff
s_mov_b32 s22, 25600
s_mov_b32 s23, 0x20000
v_lshlrev_b32 v24, 4, v1
s_mul_i32 s45, s38, 3200
s_lshl_b32 s49, s55, 10
s_add_u32 s45, s45, s49
s_add_u32 m0, s49, 131072
s_nop 0
buffer_load_dwordx4 v24, s[20:23], s45 offen lds
s_waitcnt vmcnt(19)
v_dot2_f32_bf16 v40, v96, s51, v40
v_dot2_f32_bf16 v42, v96, v96, v42
v_dot2_f32_bf16 v41, v97, s51, v41
v_dot2_f32_bf16 v43, v97, v97, v43
v_dot2_f32_bf16 v40, v98, s51, v40
v_dot2_f32_bf16 v42, v98, v98, v42
v_dot2_f32_bf16 v41, v99, s51, v41
v_dot2_f32_bf16 v43, v99, v99, v43
v_dot2_f32_bf16 v44, v100, s51, v44
v_dot2_f32_bf16 v46, v100, v100, v46
v_dot2_f32_bf16 v45, v101, s51, v45
v_dot2_f32_bf16 v47, v101, v101, v47
v_dot2_f32_bf16 v44, v102, s51, v44
v_dot2_f32_bf16 v46, v102, v102, v46
v_dot2_f32_bf16 v45, v103, s51, v45
v_dot2_f32_bf16 v47, v103, v103, v47
s_waitcnt vmcnt(17)
v_dot2_f32_bf16 v40, v104, s51, v40
v_dot2_f32_bf16 v42, v104, v104, v42
v_dot2_f32_bf16 v41, v105, s51, v41
v_dot2_f32_bf16 v43, v105, v105, v43
v_dot2_f32_bf16 v40, v106, s51, v40
v_dot2_f32_bf16 v42, v106, v106, v42
v_dot2_f32_bf16 v41, v107, s51, v41
v_dot2_f32_bf16 v43, v107, v107, v43
v_dot2_f32_bf16 v44, v108, s51, v44
v_dot2_f32_bf16 v46, v108, v108, v46
v_dot2_f32_bf16 v45, v109, s51, v45
v_dot2_f32_bf16 v47, v109, v109, v47
v_dot2_f32_bf16 v44, v110, s51, v44
v_dot2_f32_bf16 v46, v110, v110, v46
v_dot2_f32_bf16 v45, v111, s51, v45
v_dot2_f32_bf16 v47, v111, v111, v47
s_waitcnt vmcnt(15)
v_dot2_f32_bf16 v40, v112, s51, v40
v_dot2_f32_bf16 v42, v112, v112, v42
v_dot2_f32_bf16 v41, v113, s51, v41
v_dot2_f32_bf16 v43, v113, v113, v43
v_dot2_f32_bf16 v40, v114, s51, v40
v_dot2_f32_bf16 v42, v114, v114, v42
v_dot2_f32_bf16 v41, v115, s51, v41
v_dot2_f32_bf16 v43, v115, v115, v43
v_dot2_f32_bf16 v44, v116, s51, v44
v_dot2_f32_bf16 v46, v116, v116, v46
v_dot2_f32_bf16 v45, v117, s51, v45
v_dot2_f32_bf16 v47, v117, v117, v47
v_dot2_f32_bf16 v44, v118, s51, v44
v_dot2_f32_bf16 v46, v118, v118, v46
v_dot2_f32_bf16 v45, v119, s51, v45
v_dot2_f32_bf16 v47, v119, v119, v47
s_waitcnt vmcnt(13)
v_dot2_f32_bf16 v40, v120, s51, v40
v_dot2_f32_bf16 v42, v120, v120, v42
v_dot2_f32_bf16 v41, v121, s51, v41
v_dot2_f32_bf16 v43, v121, v121, v43
v_dot2_f32_bf16 v40, v122, s51, v40
v_dot2_f32_bf16 v42, v122, v122, v42
v_dot2_f32_bf16 v41, v123, s51, v41
v_dot2_f32_bf16 v43, v123, v123, v43
v_dot2_f32_bf16 v44, v124, s51, v44
v_dot2_f32_bf16 v46, v124, v124, v46
v_dot2_f32_bf16 v45, v125, s51, v45
v_dot2_f32_bf16 v47, v125, v125, v47
v_dot2_f32_bf16 v44, v126, s51, v44
v_dot2_f32_bf16 v46, v126, v126, v46
v_dot2_f32_bf16 v45, v127, s51, v45
v_dot2_f32_bf16 v47, v127, v127, v47
s_waitcnt vmcnt(11)
v_dot2_f32_bf16 v40, v128, s51, v40
v_dot2_f32_bf16 v42, v128, v128, v42
v_dot2_f32_bf16 v41, v129, s51, v41
v_dot2_f32_bf16 v43, v129, v129, v43
v_dot2_f32_bf16 v40, v130, s51, v40
v_dot2_f32_bf16 v42, v130, v130, v42
v_dot2_f32_bf16 v41, v131, s51, v41
v_dot2_f32_bf16 v43, v131, v131, v43
v_dot2_f32_bf16 v44, v132, s51, v44
v_dot2_f32_bf16 v46, v132, v132, v46
v_dot2_f32_bf16 v45, v133, s51, v45
v_dot2_f32_bf16 v47, v133, v133, v47
v_dot2_f32_bf16 v44, v134, s51, v44
v_dot2_f32_bf16 v46, v134, v134, v46
v_dot2_f32_bf16 v45, v135, s51, v45
v_dot2_f32_bf16 v47, v135, v135, v47
s_waitcnt vmcnt(9)
v_dot2_f32_bf16 v40, v136, s51, v40
v_dot2_f32_bf16 v42, v136, v136, v42
v_dot2_f32_bf16 v41, v137, s51, v41
v_dot2_f32_bf16 v43, v137, v137, v43
v_dot2_f32_bf16 v40, v138, s51, v40
v_dot2_f32_bf16 v42, v138, v138, v42
v_dot2_f32_bf16 v41, v139, s51, v41
v_dot2_f32_bf16 v43, v139, v139, v43
v_dot2_f32_bf16 v44, v140, s51, v44
v_dot2_f32_bf16 v46, v140, v140, v46
v_dot2_f32_bf16 v45, v141, s51, v45
v_dot2_f32_bf16 v47, v141, v141, v47
v_dot2_f32_bf16 v44, v142, s51, v44
v_dot2_f32_bf16 v46, v142, v142, v46
v_dot2_f32_bf16 v45, v143, s51, v45
v_dot2_f32_bf16 v47, v143, v143, v47
s_waitcnt vmcnt(7)
v_dot2_f32_bf16 v40, v144, s51, v40
v_dot2_f32_bf16 v42, v144, v144, v42
v_dot2_f32_bf16 v41, v145, s51, v41
v_dot2_f32_bf16 v43, v145, v145, v43
v_dot2_f32_bf16 v40, v146, s51, v40
v_dot2_f32_bf16 v42, v146, v146, v42
v_dot2_f32_bf16 v41, v147, s51, v41
v_dot2_f32_bf16 v43, v147, v147, v43
v_dot2_f32_bf16 v44, v148, s51, v44
v_dot2_f32_bf16 v46, v148, v148, v46
v_dot2_f32_bf16 v45, v149, s51, v45
v_dot2_f32_bf16 v47, v149, v149, v47
v_dot2_f32_bf16 v44, v150, s51, v44
v_dot2_f32_bf16 v46, v150, v150, v46
v_dot2_f32_bf16 v45, v151, s51, v45
v_dot2_f32_bf16 v47, v151, v151, v47
s_waitcnt vmcnt(5)
v_dot2_f32_bf16 v40, v152, s51, v40
v_dot2_f32_bf16 v42, v152, v152, v42
v_dot2_f32_bf16 v41, v153, s51, v41
v_dot2_f32_bf16 v43, v153, v153, v43
v_dot2_f32_bf16 v40, v154, s51, v40
v_dot2_f32_bf16 v42, v154, v154, v42
v_dot2_f32_bf16 v41, v155, s51, v41
v_dot2_f32_bf16 v43, v155, v155, v43
v_dot2_f32_bf16 v44, v156, s51, v44
v_dot2_f32_bf16 v46, v156, v156, v46
v_dot2_f32_bf16 v45, v157, s51, v45
v_dot2_f32_bf16 v47, v157, v157, v47
v_dot2_f32_bf16 v44, v158, s51, v44
v_dot2_f32_bf16 v46, v158, v158, v46
v_dot2_f32_bf16 v45, v159, s51, v45
v_dot2_f32_bf16 v47, v159, v159, v47
v_add_f32 v40, v40, v41
v_add_f32 v42, v42, v43
v_add_f32 v44, v44, v45
v_add_f32 v46, v46, v47
s_nop 1
v_add_f32_dpp v40, v40, v40 quad_perm:[1,0,3,2] row_mask:0xf bank_mask:0xf
v_add_f32_dpp v42, v42, v42 quad_perm:[1,0,3,2] row_mask:0xf bank_mask:0xf
v_add_f32_dpp v44, v44, v44 quad_perm:[1,0,3,2] row_mask:0xf bank_mask:0xf
v_add_f32_dpp v46, v46, v46 quad_perm:[1,0,3,2] row_mask:0xf bank_mask:0xf
s_nop 1
v_add_f32_dpp v40, v40, v40 quad_perm:[2,3,0,1] row_mask:0xf bank_mask:0xf
v_add_f32_dpp v42, v42, v42 quad_perm:[2,3,0,1] row_mask:0xf bank_mask:0xf
v_add_f32_dpp v44, v44, v44 quad_perm:[2,3,0,1] row_mask:0xf bank_mask:0xf
v_add_f32_dpp v46, v46, v46 quad_perm:[2,3,0,1] row_mask:0xf bank_mask:0xf
s_nop 1
v_add_f32_dpp v40, v40, v40 row_half_mirror row_mask:0xf bank_mask:0xf
v_add_f32_dpp v42, v42, v42 row_half_mirror row_mask:0xf bank_mask:0xf
v_add_f32_dpp v44, v44, v44 row_half_mirror row_mask:0xf bank_mask:0xf
v_add_f32_dpp v46, v46, v46 row_half_mirror row_mask:0xf bank_mask:0xf
s_mov_b32 s45, 0x3acccccd
s_mov_b32 s49, 0x3727c5ac
v_mul_f32 v40, s45, v40
v_mul_f32 v42, s45, v42
v_mul_f32 v44, s45, v44
v_mul_f32 v46, s45, v46
v_fma_f32 v42, -v40, v40, v42
v_fma_f32 v46, -v44, v44, v46
v_max_f32 v42, 0, v42
v_max_f32 v46, 0, v46
v_add_f32 v42, s49, v42
v_add_f32 v46, s49, v46
v_rsq_f32 v18, v42
v_rsq_f32 v19, v46
s_nop 0
v_mul_f32 v20, v40, v18
v_mul_f32 v23, v44, v19
v_sub_f32 v20, 0, v20
v_sub_f32 v23, 0, v23
v_lshlrev_b32 v24, 16, v80
v_and_b32 v25, s50, v80
v_lshlrev_b32 v26, 16, v81
v_and_b32 v27, s50, v81
v_lshlrev_b32 v28, 16, v82
v_and_b32 v29, s50, v82
v_lshlrev_b32 v30, 16, v83
v_and_b32 v31, s50, v83
v_fma_f32 v24, v24, v18, v20
v_fma_f32 v25, v25, v18, v20
v_fma_f32 v26, v26, v18, v20
v_fma_f32 v27, v27, v18, v20
v_fma_f32 v28, v28, v18, v20
v_fma_f32 v29, v29, v18, v20
v_fma_f32 v30, v30, v18, v20
v_fma_f32 v31, v31, v18, v20
v_cvt_pk_bf16_f32 v32, v24, v25
v_cvt_pk_bf16_f32 v33, v26, v27
v_cvt_pk_bf16_f32 v34, v28, v29
v_cvt_pk_bf16_f32 v35, v30, v31
ds_write_b128 v14, v[32:35] offset:0
v_lshlrev_b32 v24, 16, v84
v_and_b32 v25, s50, v84
v_lshlrev_b32 v26, 16, v85
v_and_b32 v27, s50, v85
v_lshlrev_b32 v28, 16, v86
v_and_b32 v29, s50, v86
v_lshlrev_b32 v30, 16, v87
v_and_b32 v31, s50, v87
v_fma_f32 v24, v24, v19, v23
v_fma_f32 v25, v25, v19, v23
v_fma_f32 v26, v26, v19, v23
v_fma_f32 v27, v27, v19, v23
v_fma_f32 v28, v28, v19, v23
v_fma_f32 v29, v29, v19, v23
v_fma_f32 v30, v30, v19, v23
v_fma_f32 v31, v31, v19, v23
v_cvt_pk_bf16_f32 v36, v24, v25
v_cvt_pk_bf16_f32 v37, v26, v27
v_cvt_pk_bf16_f32 v38, v28, v29
v_cvt_pk_bf16_f32 v39, v30, v31
ds_write_b128 v15, v[36:39] offset:0
s_add_u32 m0, s44, 32768
s_nop 0
buffer_load_dwordx4 v2, s[12:15], s65 offen lds
s_add_u32 m0, s44, 33792
s_nop 0
buffer_load_dwordx4 v3, s[12:15], s65 offen lds
s_add_u32 m0, s44, 49152
s_nop 0
buffer_load_dwordx4 v4, s[12:15], s65 offen lds
s_add_u32 m0, s44, 50176
s_nop 0
buffer_load_dwordx4 v5, s[12:15], s65 offen lds
v_lshlrev_b32 v24, 16, v88
v_and_b32 v25, s50, v88
v_lshlrev_b32 v26, 16, v89
v_and_b32 v27, s50, v89
v_lshlrev_b32 v28, 16, v90
v_and_b32 v29, s50, v90
v_lshlrev_b32 v30, 16, v91
v_and_b32 v31, s50, v91
v_fma_f32 v24, v24, v18, v20
v_fma_f32 v25, v25, v18, v20
v_fma_f32 v26, v26, v18, v20
v_fma_f32 v27, v27, v18, v20
v_fma_f32 v28, v28, v18, v20
v_fma_f32 v29, v29, v18, v20
v_fma_f32 v30, v30, v18, v20
v_fma_f32 v31, v31, v18, v20
v_cvt_pk_bf16_f32 v32, v24, v25
v_cvt_pk_bf16_f32 v33, v26, v27
v_cvt_pk_bf16_f32 v34, v28, v29
v_cvt_pk_bf16_f32 v35, v30, v31
v_lshlrev_b32 v24, 16, v92
v_and_b32 v25, s50, v92
v_lshlrev_b32 v26, 16, v93
v_and_b32 v27, s50, v93
v_lshlrev_b32 v28, 16, v94
v_and_b32 v29, s50, v94
v_lshlrev_b32 v30, 16, v95
v_and_b32 v31, s50, v95
v_fma_f32 v24, v24, v19, v23
v_fma_f32 v25, v25, v19, v23
v_fma_f32 v26, v26, v19, v23
v_fma_f32 v27, v27, v19, v23
v_fma_f32 v28, v28, v19, v23
v_fma_f32 v29, v29, v19, v23
v_fma_f32 v30, v30, v19, v23
v_fma_f32 v31, v31, v19, v23
v_cvt_pk_bf16_f32 v36, v24, v25
v_cvt_pk_bf16_f32 v37, v26, v27
v_cvt_pk_bf16_f32 v38, v28, v29
v_cvt_pk_bf16_f32 v39, v30, v31
s_waitcnt vmcnt(4) lgkmcnt(0)
s_cmp_eq_u32 s54, 0
s_cbranch_scc1 L_g0_4
s_barrier
L_g0_4:
s_barrier
ds_read_b128 v[40:43], v10 offset:0
ds_read_b128 v[44:47], v10 offset:4096
ds_read_b64_tr_b16 v[48:49], v6 offset:0
ds_read_b64_tr_b16 v[50:51], v6 offset:2048
ds_read_b64_tr_b16 v[52:53], v8 offset:0
ds_read_b64_tr_b16 v[54:55], v8 offset:2048
ds_read_b128 v[56:59], v11 offset:0
ds_read_b128 v[60:63], v11 offset:4096
ds_read_b64_tr_b16 v[64:65], v6 offset:8192
ds_read_b64_tr_b16 v[66:67], v6 offset:10240
ds_read_b64_tr_b16 v[68:69], v8 offset:8192
ds_read_b64_tr_b16 v[70:71], v8 offset:10240
ds_read_b128 v[224:227], v12 offset:0
ds_read_b128 v[228:231], v12 offset:4096
ds_read_b64_tr_b16 v[232:233], v6 offset:16384
ds_read_b64_tr_b16 v[234:235], v6 offset:18432
ds_read_b64_tr_b16 v[236:237], v8 offset:16384
ds_read_b64_tr_b16 v[238:239], v8 offset:18432
ds_read_b128 v[240:243], v13 offset:0
ds_read_b128 v[244:247], v13 offset:4096
ds_read_b64_tr_b16 v[248:249], v6 offset:24576
ds_read_b64_tr_b16 v[250:251], v6 offset:26624
ds_read_b64_tr_b16 v[252:253], v8 offset:24576
ds_read_b64_tr_b16 v[254:255], v8 offset:26624
ds_write_b128 v14, v[32:35] offset:16384
ds_write_b128 v15, v[36:39] offset:16384
s_add_u32 m0, s44, 65536
s_nop 0
buffer_load_dwordx4 v2, s[12:15], s66 offen lds
s_add_u32 m0, s44, 66560
s_nop 0
buffer_load_dwordx4 v3, s[12:15], s66 offen lds
s_add_u32 m0, s44, 81920
s_nop 0
buffer_load_dwordx4 v4, s[12:15], s66 offen lds
s_add_u32 m0, s44, 82944
s_nop 0
buffer_load_dwordx4 v5, s[12:15], s66 offen lds
s_waitcnt vmcnt(4) lgkmcnt(0)
s_barrier
s_setprio 1
.p2align 3
v_mfma_f32_32x32x16_bf16 v[160:175], v[48:51], v[40:43], 0
v_lshlrev_b32 v24, 16, v96
v_and_b32 v25, s50, v96
v_lshlrev_b32 v26, 16, v97
v_and_b32 v27, s50, v97
v_mfma_f32_32x32x16_bf16 v[192:207], v[48:51], v[44:47], 0
v_lshlrev_b32 v28, 16, v98
v_and_b32 v29, s50, v98
v_lshlrev_b32 v30, 16, v99
v_and_b32 v31, s50, v99
v_mfma_f32_32x32x16_bf16 v[176:191], v[52:55], v[40:43], 0
v_fma_f32 v24, v24, v18, v20
v_fma_f32 v25, v25, v18, v20
v_fma_f32 v26, v26, v18, v20
v_mfma_f32_32x32x16_bf16 v[208:223], v[52:55], v[44:47], 0
v_fma_f32 v27, v27, v18, v20
v_fma_f32 v28, v28, v18, v20
v_mfma_f32_32x32x16_bf16 v[160:175], v[64:67], v[56:59], v[160:175]
v_fma_f32 v29, v29, v18, v20
v_fma_f32 v30, v30, v18, v20
v_fma_f32 v31, v31, v18, v20
v_mfma_f32_32x32x16_bf16 v[192:207], v[64:67], v[60:63], v[192:207]
v_cvt_pk_bf16_f32 v32, v24, v25
v_cvt_pk_bf16_f32 v33, v26, v27
v_mfma_f32_32x32x16_bf16 v[176:191], v[68:71], v[56:59], v[176:191]
v_cvt_pk_bf16_f32 v34, v28, v29
v_cvt_pk_bf16_f32 v35, v30, v31
v_lshlrev_b32 v24, 16, v100
v_and_b32 v25, s50, v100
v_mfma_f32_32x32x16_bf16 v[208:223], v[68:71], v[60:63], v[208:223]
v_lshlrev_b32 v26, 16, v101
v_and_b32 v27, s50, v101
v_lshlrev_b32 v28, 16, v102
v_and_b32 v29, s50, v102
v_mfma_f32_32x32x16_bf16 v[160:175], v[232:235], v[224:227], v[160:175]
v_lshlrev_b32 v30, 16, v103
v_and_b32 v31, s50, v103
v_fma_f32 v24, v24, v19, v23
v_mfma_f32_32x32x16_bf16 v[192:207], v[232:235], v[228:231], v[192:207]
v_fma_f32 v25, v25, v19, v23
v_fma_f32 v26, v26, v19, v23
v_fma_f32 v27, v27, v19, v23
v_mfma_f32_32x32x16_bf16 v[176:191], v[236:239], v[224:227], v[176:191]
v_fma_f32 v28, v28, v19, v23
v_fma_f32 v29, v29, v19, v23
v_mfma_f32_32x32x16_bf16 v[208:223], v[236:239], v[228:231], v[208:223]
v_fma_f32 v30, v30, v19, v23
v_fma_f32 v31, v31, v19, v23
v_cvt_pk_bf16_f32 v36, v24, v25
v_mfma_f32_32x32x16_bf16 v[160:175], v[248:251], v[240:243], v[160:175]
v_cvt_pk_bf16_f32 v37, v26, v27
v_cvt_pk_bf16_f32 v38, v28, v29
v_mfma_f32_32x32x16_bf16 v[192:207], v[248:251], v[244:247], v[192:207]
v_cvt_pk_bf16_f32 v39, v30, v31
s_add_u32 s67, s66, 245760
s_cmp_eq_u32 s67, 2457600
s_cselect_b32 s67, 0, s67
s_add_u32 s68, s67, 245760
s_cmp_eq_u32 s68, 2457600
s_cselect_b32 s68, 0, s68
v_mfma_f32_32x32x16_bf16 v[176:191], v[252:255], v[240:243], v[176:191]
s_add_u32 s69, s68, 245760
s_cmp_eq_u32 s69, 2457600
s_cselect_b32 s69, 0, s69
s_add_u32 s70, s69, 245760
s_cmp_eq_u32 s70, 2457600
s_cselect_b32 s70, 0, s70
v_mfma_f32_32x32x16_bf16 v[208:223], v[252:255], v[244:247], v[208:223]
s_add_u32 s71, s70, 245760
s_cmp_eq_u32 s71, 2457600
s_cselect_b32 s71, 0, s71
s_add_u32 s72, s71, 245760
s_cmp_eq_u32 s72, 2457600
s_cselect_b32 s72, 0, s72
s_add_u32 s73, s72, 245760
s_cmp_eq_u32 s73, 2457600
s_cselect_b32 s73, 0, s73
s_setprio 0
s_barrier
ds_read_b128 v[40:43], v10 offset:16384
ds_read_b128 v[44:47], v10 offset:20480
ds_read_b64_tr_b16 v[48:49], v6 offset:32768
ds_read_b64_tr_b16 v[50:51], v6 offset:34816
ds_read_b64_tr_b16 v[52:53], v8 offset:32768
ds_read_b64_tr_b16 v[54:55], v8 offset:34816
ds_read_b128 v[56:59], v11 offset:16384
ds_read_b128 v[60:63], v11 offset:20480
ds_read_b64_tr_b16 v[64:65], v6 offset:40960
ds_read_b64_tr_b16 v[66:67], v6 offset:43008
ds_read_b64_tr_b16 v[68:69], v8 offset:40960
ds_read_b64_tr_b16 v[70:71], v8 offset:43008
ds_read_b128 v[224:227], v12 offset:16384
ds_read_b128 v[228:231], v12 offset:20480
ds_read_b64_tr_b16 v[232:233], v6 offset:49152
ds_read_b64_tr_b16 v[234:235], v6 offset:51200
ds_read_b64_tr_b16 v[236:237], v8 offset:49152
ds_read_b64_tr_b16 v[238:239], v8 offset:51200
ds_read_b128 v[240:243], v13 offset:16384
ds_read_b128 v[244:247], v13 offset:20480
ds_read_b64_tr_b16 v[248:249], v6 offset:57344
ds_read_b64_tr_b16 v[250:251], v6 offset:59392
ds_read_b64_tr_b16 v[252:253], v8 offset:57344
ds_read_b64_tr_b16 v[254:255], v8 offset:59392
ds_write_b128 v14, v[32:35] offset:0
ds_write_b128 v15, v[36:39] offset:0
s_add_u32 m0, s44, 0
s_nop 0
buffer_load_dwordx4 v2, s[12:15], s67 offen lds
s_add_u32 m0, s44, 1024
s_nop 0
buffer_load_dwordx4 v3, s[12:15], s67 offen lds
s_add_u32 m0, s44, 16384
s_nop 0
buffer_load_dwordx4 v4, s[12:15], s67 offen lds
s_add_u32 m0, s44, 17408
s_nop 0
buffer_load_dwordx4 v5, s[12:15], s67 offen lds
s_waitcnt vmcnt(4) lgkmcnt(0)
s_barrier
s_setprio 1
.p2align 3
v_mfma_f32_32x32x16_bf16 v[160:175], v[48:51], v[40:43], v[160:175]
v_lshlrev_b32 v24, 16, v104
v_and_b32 v25, s50, v104
v_lshlrev_b32 v26, 16, v105
v_and_b32 v27, s50, v105
v_mfma_f32_32x32x16_bf16 v[192:207], v[48:51], v[44:47], v[192:207]
v_lshlrev_b32 v28, 16, v106
v_and_b32 v29, s50, v106
v_lshlrev_b32 v30, 16, v107
v_and_b32 v31, s50, v107
v_mfma_f32_32x32x16_bf16 v[176:191], v[52:55], v[40:43], v[176:191]
v_fma_f32 v24, v24, v18, v20
v_fma_f32 v25, v25, v18, v20
v_mfma_f32_32x32x16_bf16 v[208:223], v[52:55], v[44:47], v[208:223]
v_fma_f32 v26, v26, v18, v20
v_fma_f32 v27, v27, v18, v20
v_mfma_f32_32x32x16_bf16 v[160:175], v[64:67], v[56:59], v[160:175]
v_fma_f32 v28, v28, v18, v20
v_fma_f32 v29, v29, v18, v20
v_mfma_f32_32x32x16_bf16 v[192:207], v[64:67], v[60:63], v[192:207]
v_fma_f32 v30, v30, v18, v20
v_fma_f32 v31, v31, v18, v20
v_mfma_f32_32x32x16_bf16 v[176:191], v[68:71], v[56:59], v[176:191]
v_cvt_pk_bf16_f32 v32, v24, v25
v_cvt_pk_bf16_f32 v33, v26, v27
v_mfma_f32_32x32x16_bf16 v[208:223], v[68:71], v[60:63], v[208:223]
v_cvt_pk_bf16_f32 v34, v28, v29
v_cvt_pk_bf16_f32 v35, v30, v31
v_mfma_f32_32x32x16_bf16 v[160:175], v[232:235], v[224:227], v[160:175]
v_lshlrev_b32 v24, 16, v108
v_and_b32 v25, s50, v108
v_lshlrev_b32 v26, 16, v109
v_and_b32 v27, s50, v109
v_mfma_f32_32x32x16_bf16 v[192:207], v[232:235], v[228:231], v[192:207]
v_lshlrev_b32 v28, 16, v110
v_and_b32 v29, s50, v110
v_lshlrev_b32 v30, 16, v111
v_and_b32 v31, s50, v111
v_mfma_f32_32x32x16_bf16 v[176:191], v[236:239], v[224:227], v[176:191]
v_fma_f32 v24, v24, v19, v23
v_fma_f32 v25, v25, v19, v23
v_mfma_f32_32x32x16_bf16 v[208:223], v[236:239], v[228:231], v[208:223]
v_fma_f32 v26, v26, v19, v23
v_fma_f32 v27, v27, v19, v23
v_mfma_f32_32x32x16_bf16 v[160:175], v[248:251], v[240:243], v[160:175]
v_fma_f32 v28, v28, v19, v23
v_fma_f32 v29, v29, v19, v23
v_mfma_f32_32x32x16_bf16 v[192:207], v[248:251], v[244:247], v[192:207]
v_fma_f32 v30, v30, v19, v23
v_fma_f32 v31, v31, v19, v23
v_mfma_f32_32x32x16_bf16 v[176:191], v[252:255], v[240:243], v[176:191]
v_cvt_pk_bf16_f32 v36, v24, v25
v_cvt_pk_bf16_f32 v37, v26, v27
v_mfma_f32_32x32x16_bf16 v[208:223], v[252:255], v[244:247], v[208:223]
v_cvt_pk_bf16_f32 v38, v28, v29
v_cvt_pk_bf16_f32 v39, v30, v31
s_setprio 0
s_barrier
ds_read_b128 v[40:43], v10 offset:0
ds_read_b128 v[44:47], v10 offset:4096
ds_read_b64_tr_b16 v[48:49], v7 offset:0
ds_read_b64_tr_b16 v[50:51], v7 offset:2048
ds_read_b64_tr_b16 v[52:53], v9 offset:0
ds_read_b64_tr_b16 v[54:55], v9 offset:2048
ds_read_b128 v[56:59], v11 offset:0
ds_read_b128 v[60:63], v11 offset:4096
ds_read_b64_tr_b16 v[64:65], v7 offset:8192
ds_read_b64_tr_b16 v[66:67], v7 offset:10240
ds_read_b64_tr_b16 v[68:69], v9 offset:8192
ds_read_b64_tr_b16 v[70:71], v9 offset:10240
ds_read_b128 v[224:227], v12 offset:0
ds_read_b128 v[228:231], v12 offset:4096
ds_read_b64_tr_b16 v[232:233], v7 offset:16384
ds_read_b64_tr_b16 v[234:235], v7 offset:18432
ds_read_b64_tr_b16 v[236:237], v9 offset:16384
ds_read_b64_tr_b16 v[238:239], v9 offset:18432
ds_read_b128 v[240:243], v13 offset:0
ds_read_b128 v[244:247], v13 offset:4096
ds_read_b64_tr_b16 v[248:249], v7 offset:24576
ds_read_b64_tr_b16 v[250:251], v7 offset:26624
ds_read_b64_tr_b16 v[252:253], v9 offset:24576
ds_read_b64_tr_b16 v[254:255], v9 offset:26624
ds_write_b128 v14, v[32:35] offset:16384
ds_write_b128 v15, v[36:39] offset:16384
s_add_u32 m0, s44, 32768
s_nop 0
buffer_load_dwordx4 v2, s[12:15], s68 offen lds
s_add_u32 m0, s44, 33792
s_nop 0
buffer_load_dwordx4 v3, s[12:15], s68 offen lds
s_add_u32 m0, s44, 49152
s_nop 0
buffer_load_dwordx4 v4, s[12:15], s68 offen lds
s_add_u32 m0, s44, 50176
s_nop 0
buffer_load_dwordx4 v5, s[12:15], s68 offen lds
s_waitcnt vmcnt(4) lgkmcnt(0)
s_barrier
s_setprio 1
.p2align 3
v_mfma_f32_32x32x16_bf16 v[160:175], v[48:51], v[40:43], v[160:175]
v_lshlrev_b32 v24, 16, v112
v_and_b32 v25, s50, v112
v_lshlrev_b32 v26, 16, v113
v_and_b32 v27, s50, v113
v_mfma_f32_32x32x16_bf16 v[192:207], v[48:51], v[44:47], v[192:207]
v_lshlrev_b32 v28, 16, v114
v_and_b32 v29, s50, v114
v_lshlrev_b32 v30, 16, v115
v_and_b32 v31, s50, v115
v_mfma_f32_32x32x16_bf16 v[176:191], v[52:55], v[40:43], v[176:191]
v_fma_f32 v24, v24, v18, v20
v_fma_f32 v25, v25, v18, v20
v_mfma_f32_32x32x16_bf16 v[208:223], v[52:55], v[44:47], v[208:223]
v_fma_f32 v26, v26, v18, v20
v_fma_f32 v27, v27, v18, v20
v_mfma_f32_32x32x16_bf16 v[160:175], v[64:67], v[56:59], v[160:175]
v_fma_f32 v28, v28, v18, v20
v_fma_f32 v29, v29, v18, v20
v_mfma_f32_32x32x16_bf16 v[192:207], v[64:67], v[60:63], v[192:207]
v_fma_f32 v30, v30, v18, v20
v_fma_f32 v31, v31, v18, v20
v_mfma_f32_32x32x16_bf16 v[176:191], v[68:71], v[56:59], v[176:191]
v_cvt_pk_bf16_f32 v32, v24, v25
v_cvt_pk_bf16_f32 v33, v26, v27
v_mfma_f32_32x32x16_bf16 v[208:223], v[68:71], v[60:63], v[208:223]
v_cvt_pk_bf16_f32 v34, v28, v29
v_cvt_pk_bf16_f32 v35, v30, v31
v_mfma_f32_32x32x16_bf16 v[160:175], v[232:235], v[224:227], v[160:175]
v_lshlrev_b32 v24, 16, v116
v_and_b32 v25, s50, v116
v_lshlrev_b32 v26, 16, v117
v_and_b32 v27, s50, v117
v_mfma_f32_32x32x16_bf16 v[192:207], v[232:235], v[228:231], v[192:207]
v_lshlrev_b32 v28, 16, v118
v_and_b32 v29, s50, v118
v_lshlrev_b32 v30, 16, v119
v_and_b32 v31, s50, v119
v_mfma_f32_32x32x16_bf16 v[176:191], v[236:239], v[224:227], v[176:191]
v_fma_f32 v24, v24, v19, v23
v_fma_f32 v25, v25, v19, v23
v_mfma_f32_32x32x16_bf16 v[208:223], v[236:239], v[228:231], v[208:223]
v_fma_f32 v26, v26, v19, v23
v_fma_f32 v27, v27, v19, v23
v_mfma_f32_32x32x16_bf16 v[160:175], v[248:251], v[240:243], v[160:175]
v_fma_f32 v28, v28, v19, v23
v_fma_f32 v29, v29, v19, v23
v_mfma_f32_32x32x16_bf16 v[192:207], v[248:251], v[244:247], v[192:207]
v_fma_f32 v30, v30, v19, v23
v_fma_f32 v31, v31, v19, v23
v_mfma_f32_32x32x16_bf16 v[176:191], v[252:255], v[240:243], v[176:191]
v_cvt_pk_bf16_f32 v36, v24, v25
v_cvt_pk_bf16_f32 v37, v26, v27
v_mfma_f32_32x32x16_bf16 v[208:223], v[252:255], v[244:247], v[208:223]
v_cvt_pk_bf16_f32 v38, v28, v29
v_cvt_pk_bf16_f32 v39, v30, v31
s_setprio 0
s_barrier
ds_read_b128 v[40:43], v10 offset:16384
ds_read_b128 v[44:47], v10 offset:20480
ds_read_b64_tr_b16 v[48:49], v6 offset:0
ds_read_b64_tr_b16 v[50:51], v6 offset:2048
ds_read_b64_tr_b16 v[52:53], v8 offset:0
ds_read_b64_tr_b16 v[54:55], v8 offset:2048
ds_read_b128 v[56:59], v11 offset:16384
ds_read_b128 v[60:63], v11 offset:20480
ds_read_b64_tr_b16 v[64:65], v6 offset:8192
ds_read_b64_tr_b16 v[66:67], v6 offset:10240
ds_read_b64_tr_b16 v[68:69], v8 offset:8192
ds_read_b64_tr_b16 v[70:71], v8 offset:10240
ds_read_b128 v[224:227], v12 offset:16384
ds_read_b128 v[228:231], v12 offset:20480
ds_read_b64_tr_b16 v[232:233], v6 offset:16384
ds_read_b64_tr_b16 v[234:235], v6 offset:18432
ds_read_b64_tr_b16 v[236:237], v8 offset:16384
ds_read_b64_tr_b16 v[238:239], v8 offset:18432
ds_read_b128 v[240:243], v13 offset:16384
ds_read_b128 v[244:247], v13 offset:20480
ds_read_b64_tr_b16 v[248:249], v6 offset:24576
ds_read_b64_tr_b16 v[250:251], v6 offset:26624
ds_read_b64_tr_b16 v[252:253], v8 offset:24576
ds_read_b64_tr_b16 v[254:255], v8 offset:26624
ds_write_b128 v14, v[32:35] offset:0
ds_write_b128 v15, v[36:39] offset:0
s_add_u32 m0, s44, 65536
s_nop 0
buffer_load_dwordx4 v2, s[12:15], s69 offen lds
s_add_u32 m0, s44, 66560
s_nop 0
buffer_load_dwordx4 v3, s[12:15], s69 offen lds
s_add_u32 m0, s44, 81920
s_nop 0
buffer_load_dwordx4 v4, s[12:15], s69 offen lds
s_add_u32 m0, s44, 82944
s_nop 0
buffer_load_dwordx4 v5, s[12:15], s69 offen lds
s_waitcnt vmcnt(4) lgkmcnt(0)
s_barrier
s_setprio 1
.p2align 3
v_mfma_f32_32x32x16_bf16 v[160:175], v[48:51], v[40:43], v[160:175]
v_lshlrev_b32 v24, 16, v120
v_and_b32 v25, s50, v120
v_lshlrev_b32 v26, 16, v121
v_and_b32 v27, s50, v121
v_mfma_f32_32x32x16_bf16 v[192:207], v[48:51], v[44:47], v[192:207]
v_lshlrev_b32 v28, 16, v122
v_and_b32 v29, s50, v122
v_lshlrev_b32 v30, 16, v123
v_and_b32 v31, s50, v123
v_mfma_f32_32x32x16_bf16 v[176:191], v[52:55], v[40:43], v[176:191]
v_fma_f32 v24, v24, v18, v20
v_fma_f32 v25, v25, v18, v20
v_mfma_f32_32x32x16_bf16 v[208:223], v[52:55], v[44:47], v[208:223]
v_fma_f32 v26, v26, v18, v20
v_fma_f32 v27, v27, v18, v20
v_mfma_f32_32x32x16_bf16 v[160:175], v[64:67], v[56:59], v[160:175]
v_fma_f32 v28, v28, v18, v20
v_fma_f32 v29, v29, v18, v20
v_mfma_f32_32x32x16_bf16 v[192:207], v[64:67], v[60:63], v[192:207]
v_fma_f32 v30, v30, v18, v20
v_fma_f32 v31, v31, v18, v20
v_mfma_f32_32x32x16_bf16 v[176:191], v[68:71], v[56:59], v[176:191]
v_cvt_pk_bf16_f32 v32, v24, v25
v_cvt_pk_bf16_f32 v33, v26, v27
v_mfma_f32_32x32x16_bf16 v[208:223], v[68:71], v[60:63], v[208:223]
v_cvt_pk_bf16_f32 v34, v28, v29
v_cvt_pk_bf16_f32 v35, v30, v31
v_mfma_f32_32x32x16_bf16 v[160:175], v[232:235], v[224:227], v[160:175]
v_lshlrev_b32 v24, 16, v124
v_and_b32 v25, s50, v124
v_lshlrev_b32 v26, 16, v125
v_and_b32 v27, s50, v125
v_mfma_f32_32x32x16_bf16 v[192:207], v[232:235], v[228:231], v[192:207]
v_lshlrev_b32 v28, 16, v126
v_and_b32 v29, s50, v126
v_lshlrev_b32 v30, 16, v127
v_and_b32 v31, s50, v127
v_mfma_f32_32x32x16_bf16 v[176:191], v[236:239], v[224:227], v[176:191]
v_fma_f32 v24, v24, v19, v23
v_fma_f32 v25, v25, v19, v23
v_mfma_f32_32x32x16_bf16 v[208:223], v[236:239], v[228:231], v[208:223]
v_fma_f32 v26, v26, v19, v23
v_fma_f32 v27, v27, v19, v23
v_mfma_f32_32x32x16_bf16 v[160:175], v[248:251], v[240:243], v[160:175]
v_fma_f32 v28, v28, v19, v23
v_fma_f32 v29, v29, v19, v23
v_mfma_f32_32x32x16_bf16 v[192:207], v[248:251], v[244:247], v[192:207]
v_fma_f32 v30, v30, v19, v23
v_fma_f32 v31, v31, v19, v23
v_mfma_f32_32x32x16_bf16 v[176:191], v[252:255], v[240:243], v[176:191]
v_cvt_pk_bf16_f32 v36, v24, v25
v_cvt_pk_bf16_f32 v37, v26, v27
v_mfma_f32_32x32x16_bf16 v[208:223], v[252:255], v[244:247], v[208:223]
v_cvt_pk_bf16_f32 v38, v28, v29
v_cvt_pk_bf16_f32 v39, v30, v31
s_setprio 0
s_barrier
ds_read_b128 v[40:43], v10 offset:0
ds_read_b128 v[44:47], v10 offset:4096
ds_read_b64_tr_b16 v[48:49], v6 offset:32768
ds_read_b64_tr_b16 v[50:51], v6 offset:34816
ds_read_b64_tr_b16 v[52:53], v8 offset:32768
ds_read_b64_tr_b16 v[54:55], v8 offset:34816
ds_read_b128 v[56:59], v11 offset:0
ds_read_b128 v[60:63], v11 offset:4096
ds_read_b64_tr_b16 v[64:65], v6 offset:40960
ds_read_b64_tr_b16 v[66:67], v6 offset:43008
ds_read_b64_tr_b16 v[68:69], v8 offset:40960
ds_read_b64_tr_b16 v[70:71], v8 offset:43008
ds_read_b128 v[224:227], v12 offset:0
ds_read_b128 v[228:231], v12 offset:4096
ds_read_b64_tr_b16 v[232:233], v6 offset:49152
ds_read_b64_tr_b16 v[234:235], v6 offset:51200
ds_read_b64_tr_b16 v[236:237], v8 offset:49152
ds_read_b64_tr_b16 v[238:239], v8 offset:51200
ds_read_b128 v[240:243], v13 offset:0
ds_read_b128 v[244:247], v13 offset:4096
ds_read_b64_tr_b16 v[248:249], v6 offset:57344
ds_read_b64_tr_b16 v[250:251], v6 offset:59392
ds_read_b64_tr_b16 v[252:253], v8 offset:57344
ds_read_b64_tr_b16 v[254:255], v8 offset:59392
ds_write_b128 v14, v[32:35] offset:16384
ds_write_b128 v15, v[36:39] offset:16384
s_add_u32 m0, s44, 0
s_nop 0
buffer_load_dwordx4 v2, s[12:15], s70 offen lds
s_add_u32 m0, s44, 1024
s_nop 0
buffer_load_dwordx4 v3, s[12:15], s70 offen lds
s_add_u32 m0, s44, 16384
s_nop 0
buffer_load_dwordx4 v4, s[12:15], s70 offen lds
s_add_u32 m0, s44, 17408
s_nop 0
buffer_load_dwordx4 v5, s[12:15], s70 offen lds
s_waitcnt vmcnt(4) lgkmcnt(0)
s_barrier
s_setprio 1
.p2align 3
v_mfma_f32_32x32x16_bf16 v[160:175], v[48:51], v[40:43], v[160:175]
v_lshlrev_b32 v24, 16, v128
v_and_b32 v25, s50, v128
v_lshlrev_b32 v26, 16, v129
v_and_b32 v27, s50, v129
v_mfma_f32_32x32x16_bf16 v[192:207], v[48:51], v[44:47], v[192:207]
v_lshlrev_b32 v28, 16, v130
v_and_b32 v29, s50, v130
v_lshlrev_b32 v30, 16, v131
v_and_b32 v31, s50, v131
v_mfma_f32_32x32x16_bf16 v[176:191], v[52:55], v[40:43], v[176:191]
v_fma_f32 v24, v24, v18, v20
v_fma_f32 v25, v25, v18, v20
v_mfma_f32_32x32x16_bf16 v[208:223], v[52:55], v[44:47], v[208:223]
v_fma_f32 v26, v26, v18, v20
v_fma_f32 v27, v27, v18, v20
v_mfma_f32_32x32x16_bf16 v[160:175], v[64:67], v[56:59], v[160:175]
v_fma_f32 v28, v28, v18, v20
v_fma_f32 v29, v29, v18, v20
v_mfma_f32_32x32x16_bf16 v[192:207], v[64:67], v[60:63], v[192:207]
v_fma_f32 v30, v30, v18, v20
v_fma_f32 v31, v31, v18, v20
v_mfma_f32_32x32x16_bf16 v[176:191], v[68:71], v[56:59], v[176:191]
v_cvt_pk_bf16_f32 v32, v24, v25
v_cvt_pk_bf16_f32 v33, v26, v27
v_mfma_f32_32x32x16_bf16 v[208:223], v[68:71], v[60:63], v[208:223]
v_cvt_pk_bf16_f32 v34, v28, v29
v_cvt_pk_bf16_f32 v35, v30, v31
v_mfma_f32_32x32x16_bf16 v[160:175], v[232:235], v[224:227], v[160:175]
v_lshlrev_b32 v24, 16, v132
v_and_b32 v25, s50, v132
v_lshlrev_b32 v26, 16, v133
v_and_b32 v27, s50, v133
v_mfma_f32_32x32x16_bf16 v[192:207], v[232:235], v[228:231], v[192:207]
v_lshlrev_b32 v28, 16, v134
v_and_b32 v29, s50, v134
v_lshlrev_b32 v30, 16, v135
v_and_b32 v31, s50, v135
v_mfma_f32_32x32x16_bf16 v[176:191], v[236:239], v[224:227], v[176:191]
v_fma_f32 v24, v24, v19, v23
v_fma_f32 v25, v25, v19, v23
v_mfma_f32_32x32x16_bf16 v[208:223], v[236:239], v[228:231], v[208:223]
v_fma_f32 v26, v26, v19, v23
v_fma_f32 v27, v27, v19, v23
v_mfma_f32_32x32x16_bf16 v[160:175], v[248:251], v[240:243], v[160:175]
v_fma_f32 v28, v28, v19, v23
v_fma_f32 v29, v29, v19, v23
v_mfma_f32_32x32x16_bf16 v[192:207], v[248:251], v[244:247], v[192:207]
v_fma_f32 v30, v30, v19, v23
v_fma_f32 v31, v31, v19, v23
v_mfma_f32_32x32x16_bf16 v[176:191], v[252:255], v[240:243], v[176:191]
v_cvt_pk_bf16_f32 v36, v24, v25
v_cvt_pk_bf16_f32 v37, v26, v27
v_mfma_f32_32x32x16_bf16 v[208:223], v[252:255], v[244:247], v[208:223]
v_cvt_pk_bf16_f32 v38, v28, v29
v_cvt_pk_bf16_f32 v39, v30, v31
s_setprio 0
s_barrier
ds_read_b128 v[40:43], v10 offset:16384
ds_read_b128 v[44:47], v10 offset:20480
ds_read_b64_tr_b16 v[48:49], v7 offset:0
ds_read_b64_tr_b16 v[50:51], v7 offset:2048
ds_read_b64_tr_b16 v[52:53], v9 offset:0
ds_read_b64_tr_b16 v[54:55], v9 offset:2048
ds_read_b128 v[56:59], v11 offset:16384
ds_read_b128 v[60:63], v11 offset:20480
ds_read_b64_tr_b16 v[64:65], v7 offset:8192
ds_read_b64_tr_b16 v[66:67], v7 offset:10240
ds_read_b64_tr_b16 v[68:69], v9 offset:8192
ds_read_b64_tr_b16 v[70:71], v9 offset:10240
ds_read_b128 v[224:227], v12 offset:16384
ds_read_b128 v[228:231], v12 offset:20480
ds_read_b64_tr_b16 v[232:233], v7 offset:16384
ds_read_b64_tr_b16 v[234:235], v7 offset:18432
ds_read_b64_tr_b16 v[236:237], v9 offset:16384
ds_read_b64_tr_b16 v[238:239], v9 offset:18432
ds_read_b128 v[240:243], v13 offset:16384
ds_read_b128 v[244:247], v13 offset:20480
ds_read_b64_tr_b16 v[248:249], v7 offset:24576
ds_read_b64_tr_b16 v[250:251], v7 offset:26624
ds_read_b64_tr_b16 v[252:253], v9 offset:24576
ds_read_b64_tr_b16 v[254:255], v9 offset:26624
ds_write_b128 v14, v[32:35] offset:0
ds_write_b128 v15, v[36:39] offset:0
s_add_u32 m0, s44, 32768
s_nop 0
buffer_load_dwordx4 v2, s[12:15], s71 offen lds
s_add_u32 m0, s44, 33792
s_nop 0
buffer_load_dwordx4 v3, s[12:15], s71 offen lds
s_add_u32 m0, s44, 49152
s_nop 0
buffer_load_dwordx4 v4, s[12:15], s71 offen lds
s_add_u32 m0, s44, 50176
s_nop 0
buffer_load_dwordx4 v5, s[12:15], s71 offen lds
s_waitcnt vmcnt(4) lgkmcnt(0)
s_barrier
s_setprio 1
.p2align 3
v_mfma_f32_32x32x16_bf16 v[160:175], v[48:51], v[40:43], v[160:175]
v_lshlrev_b32 v24, 16, v136
v_and_b32 v25, s50, v136
v_lshlrev_b32 v26, 16, v137
v_and_b32 v27, s50, v137
v_mfma_f32_32x32x16_bf16 v[192:207], v[48:51], v[44:47], v[192:207]
v_lshlrev_b32 v28, 16, v138
v_and_b32 v29, s50, v138
v_lshlrev_b32 v30, 16, v139
v_and_b32 v31, s50, v139
v_mfma_f32_32x32x16_bf16 v[176:191], v[52:55], v[40:43], v[176:191]
v_fma_f32 v24, v24, v18, v20
v_fma_f32 v25, v25, v18, v20
v_mfma_f32_32x32x16_bf16 v[208:223], v[52:55], v[44:47], v[208:223]
v_fma_f32 v26, v26, v18, v20
v_fma_f32 v27, v27, v18, v20
v_mfma_f32_32x32x16_bf16 v[160:175], v[64:67], v[56:59], v[160:175]
v_fma_f32 v28, v28, v18, v20
v_fma_f32 v29, v29, v18, v20
v_mfma_f32_32x32x16_bf16 v[192:207], v[64:67], v[60:63], v[192:207]
v_fma_f32 v30, v30, v18, v20
v_fma_f32 v31, v31, v18, v20
v_mfma_f32_32x32x16_bf16 v[176:191], v[68:71], v[56:59], v[176:191]
v_cvt_pk_bf16_f32 v32, v24, v25
v_cvt_pk_bf16_f32 v33, v26, v27
v_mfma_f32_32x32x16_bf16 v[208:223], v[68:71], v[60:63], v[208:223]
v_cvt_pk_bf16_f32 v34, v28, v29
v_cvt_pk_bf16_f32 v35, v30, v31
v_mfma_f32_32x32x16_bf16 v[160:175], v[232:235], v[224:227], v[160:175]
v_lshlrev_b32 v24, 16, v140
v_and_b32 v25, s50, v140
v_lshlrev_b32 v26, 16, v141
v_and_b32 v27, s50, v141
v_mfma_f32_32x32x16_bf16 v[192:207], v[232:235], v[228:231], v[192:207]
v_lshlrev_b32 v28, 16, v142
v_and_b32 v29, s50, v142
v_lshlrev_b32 v30, 16, v143
v_and_b32 v31, s50, v143
v_mfma_f32_32x32x16_bf16 v[176:191], v[236:239], v[224:227], v[176:191]
v_fma_f32 v24, v24, v19, v23
v_fma_f32 v25, v25, v19, v23
v_mfma_f32_32x32x16_bf16 v[208:223], v[236:239], v[228:231], v[208:223]
v_fma_f32 v26, v26, v19, v23
v_fma_f32 v27, v27, v19, v23
v_mfma_f32_32x32x16_bf16 v[160:175], v[248:251], v[240:243], v[160:175]
v_fma_f32 v28, v28, v19, v23
v_fma_f32 v29, v29, v19, v23
v_mfma_f32_32x32x16_bf16 v[192:207], v[248:251], v[244:247], v[192:207]
v_fma_f32 v30, v30, v19, v23
v_fma_f32 v31, v31, v19, v23
v_mfma_f32_32x32x16_bf16 v[176:191], v[252:255], v[240:243], v[176:191]
v_cvt_pk_bf16_f32 v36, v24, v25
v_cvt_pk_bf16_f32 v37, v26, v27
v_mfma_f32_32x32x16_bf16 v[208:223], v[252:255], v[244:247], v[208:223]
v_cvt_pk_bf16_f32 v38, v28, v29
v_cvt_pk_bf16_f32 v39, v30, v31
s_setprio 0
s_barrier
ds_read_b128 v[40:43], v10 offset:0
ds_read_b128 v[44:47], v10 offset:4096
ds_read_b64_tr_b16 v[48:49], v6 offset:0
ds_read_b64_tr_b16 v[50:51], v6 offset:2048
ds_read_b64_tr_b16 v[52:53], v8 offset:0
ds_read_b64_tr_b16 v[54:55], v8 offset:2048
ds_read_b128 v[56:59], v11 offset:0
ds_read_b128 v[60:63], v11 offset:4096
ds_read_b64_tr_b16 v[64:65], v6 offset:8192
ds_read_b64_tr_b16 v[66:67], v6 offset:10240
ds_read_b64_tr_b16 v[68:69], v8 offset:8192
ds_read_b64_tr_b16 v[70:71], v8 offset:10240
ds_read_b128 v[224:227], v12 offset:0
ds_read_b128 v[228:231], v12 offset:4096
ds_read_b64_tr_b16 v[232:233], v6 offset:16384
ds_read_b64_tr_b16 v[234:235], v6 offset:18432
ds_read_b64_tr_b16 v[236:237], v8 offset:16384
ds_read_b64_tr_b16 v[238:239], v8 offset:18432
ds_read_b128 v[240:243], v13 offset:0
ds_read_b128 v[244:247], v13 offset:4096
ds_read_b64_tr_b16 v[248:249], v6 offset:24576
ds_read_b64_tr_b16 v[250:251], v6 offset:26624
ds_read_b64_tr_b16 v[252:253], v8 offset:24576
ds_read_b64_tr_b16 v[254:255], v8 offset:26624
ds_write_b128 v14, v[32:35] offset:16384
ds_write_b128 v15, v[36:39] offset:16384
s_add_u32 m0, s44, 65536
s_nop 0
buffer_load_dwordx4 v2, s[12:15], s72 offen lds
s_add_u32 m0, s44, 66560
s_nop 0
buffer_load_dwordx4 v3, s[12:15], s72 offen lds
s_add_u32 m0, s44, 81920
s_nop 0
buffer_load_dwordx4 v4, s[12:15], s72 offen lds
s_add_u32 m0, s44, 82944
s_nop 0
buffer_load_dwordx4 v5, s[12:15], s72 offen lds
s_waitcnt vmcnt(4) lgkmcnt(0)
s_barrier
s_setprio 1
.p2align 3
v_mfma_f32_32x32x16_bf16 v[160:175], v[48:51], v[40:43], v[160:175]
v_lshlrev_b32 v24, 16, v144
v_and_b32 v25, s50, v144
v_lshlrev_b32 v26, 16, v145
v_and_b32 v27, s50, v145
v_mfma_f32_32x32x16_bf16 v[192:207], v[48:51], v[44:47], v[192:207]
v_lshlrev_b32 v28, 16, v146
v_and_b32 v29, s50, v146
v_lshlrev_b32 v30, 16, v147
v_and_b32 v31, s50, v147
v_mfma_f32_32x32x16_bf16 v[176:191], v[52:55], v[40:43], v[176:191]
v_fma_f32 v24, v24, v18, v20
v_fma_f32 v25, v25, v18, v20
v_mfma_f32_32x32x16_bf16 v[208:223], v[52:55], v[44:47], v[208:223]
v_fma_f32 v26, v26, v18, v20
v_fma_f32 v27, v27, v18, v20
v_mfma_f32_32x32x16_bf16 v[160:175], v[64:67], v[56:59], v[160:175]
v_fma_f32 v28, v28, v18, v20
v_fma_f32 v29, v29, v18, v20
v_mfma_f32_32x32x16_bf16 v[192:207], v[64:67], v[60:63], v[192:207]
v_fma_f32 v30, v30, v18, v20
v_fma_f32 v31, v31, v18, v20
v_mfma_f32_32x32x16_bf16 v[176:191], v[68:71], v[56:59], v[176:191]
v_cvt_pk_bf16_f32 v32, v24, v25
v_cvt_pk_bf16_f32 v33, v26, v27
v_mfma_f32_32x32x16_bf16 v[208:223], v[68:71], v[60:63], v[208:223]
v_cvt_pk_bf16_f32 v34, v28, v29
v_cvt_pk_bf16_f32 v35, v30, v31
v_mfma_f32_32x32x16_bf16 v[160:175], v[232:235], v[224:227], v[160:175]
v_lshlrev_b32 v24, 16, v148
v_and_b32 v25, s50, v148
v_lshlrev_b32 v26, 16, v149
v_and_b32 v27, s50, v149
v_mfma_f32_32x32x16_bf16 v[192:207], v[232:235], v[228:231], v[192:207]
v_lshlrev_b32 v28, 16, v150
v_and_b32 v29, s50, v150
v_lshlrev_b32 v30, 16, v151
v_and_b32 v31, s50, v151
v_mfma_f32_32x32x16_bf16 v[176:191], v[236:239], v[224:227], v[176:191]
v_fma_f32 v24, v24, v19, v23
v_fma_f32 v25, v25, v19, v23
v_mfma_f32_32x32x16_bf16 v[208:223], v[236:239], v[228:231], v[208:223]
v_fma_f32 v26, v26, v19, v23
v_fma_f32 v27, v27, v19, v23
v_mfma_f32_32x32x16_bf16 v[160:175], v[248:251], v[240:243], v[160:175]
v_fma_f32 v28, v28, v19, v23
v_fma_f32 v29, v29, v19, v23
v_mfma_f32_32x32x16_bf16 v[192:207], v[248:251], v[244:247], v[192:207]
v_fma_f32 v30, v30, v19, v23
v_fma_f32 v31, v31, v19, v23
v_mfma_f32_32x32x16_bf16 v[176:191], v[252:255], v[240:243], v[176:191]
v_cvt_pk_bf16_f32 v36, v24, v25
v_cvt_pk_bf16_f32 v37, v26, v27
v_mfma_f32_32x32x16_bf16 v[208:223], v[252:255], v[244:247], v[208:223]
v_cvt_pk_bf16_f32 v38, v28, v29
v_cvt_pk_bf16_f32 v39, v30, v31
s_setprio 0
s_barrier
ds_read_b128 v[40:43], v10 offset:16384
ds_read_b128 v[44:47], v10 offset:20480
ds_read_b64_tr_b16 v[48:49], v6 offset:32768
ds_read_b64_tr_b16 v[50:51], v6 offset:34816
ds_read_b64_tr_b16 v[52:53], v8 offset:32768
ds_read_b64_tr_b16 v[54:55], v8 offset:34816
ds_read_b128 v[56:59], v11 offset:16384
ds_read_b128 v[60:63], v11 offset:20480
ds_read_b64_tr_b16 v[64:65], v6 offset:40960
ds_read_b64_tr_b16 v[66:67], v6 offset:43008
ds_read_b64_tr_b16 v[68:69], v8 offset:40960
ds_read_b64_tr_b16 v[70:71], v8 offset:43008
ds_read_b128 v[224:227], v12 offset:16384
ds_read_b128 v[228:231], v12 offset:20480
ds_read_b64_tr_b16 v[232:233], v6 offset:49152
ds_read_b64_tr_b16 v[234:235], v6 offset:51200
ds_read_b64_tr_b16 v[236:237], v8 offset:49152
ds_read_b64_tr_b16 v[238:239], v8 offset:51200
ds_read_b128 v[240:243], v13 offset:16384
ds_read_b128 v[244:247], v13 offset:20480
ds_read_b64_tr_b16 v[248:249], v6 offset:57344
ds_read_b64_tr_b16 v[250:251], v6 offset:59392
ds_read_b64_tr_b16 v[252:253], v8 offset:57344
ds_read_b64_tr_b16 v[254:255], v8 offset:59392
ds_write_b128 v14, v[32:35] offset:0
ds_write_b128 v15, v[36:39] offset:0
s_add_u32 m0, s44, 0
s_nop 0
buffer_load_dwordx4 v2, s[12:15], s73 offen lds
s_add_u32 m0, s44, 1024
s_nop 0
buffer_load_dwordx4 v3, s[12:15], s73 offen lds
s_add_u32 m0, s44, 16384
s_nop 0
buffer_load_dwordx4 v4, s[12:15], s73 offen lds
s_add_u32 m0, s44, 17408
s_nop 0
buffer_load_dwordx4 v5, s[12:15], s73 offen lds
s_waitcnt vmcnt(4) lgkmcnt(0)
s_barrier
s_setprio 1
.p2align 3
v_mfma_f32_32x32x16_bf16 v[160:175], v[48:51], v[40:43], v[160:175]
v_lshlrev_b32 v24, 16, v152
v_and_b32 v25, s50, v152
v_lshlrev_b32 v26, 16, v153
v_and_b32 v27, s50, v153
v_mfma_f32_32x32x16_bf16 v[192:207], v[48:51], v[44:47], v[192:207]
v_lshlrev_b32 v28, 16, v154
v_and_b32 v29, s50, v154
v_lshlrev_b32 v30, 16, v155
v_and_b32 v31, s50, v155
v_mfma_f32_32x32x16_bf16 v[176:191], v[52:55], v[40:43], v[176:191]
v_fma_f32 v24, v24, v18, v20
v_fma_f32 v25, v25, v18, v20
v_mfma_f32_32x32x16_bf16 v[208:223], v[52:55], v[44:47], v[208:223]
v_fma_f32 v26, v26, v18, v20
v_fma_f32 v27, v27, v18, v20
v_mfma_f32_32x32x16_bf16 v[160:175], v[64:67], v[56:59], v[160:175]
v_fma_f32 v28, v28, v18, v20
v_fma_f32 v29, v29, v18, v20
v_mfma_f32_32x32x16_bf16 v[192:207], v[64:67], v[60:63], v[192:207]
v_fma_f32 v30, v30, v18, v20
v_fma_f32 v31, v31, v18, v20
v_mfma_f32_32x32x16_bf16 v[176:191], v[68:71], v[56:59], v[176:191]
v_cvt_pk_bf16_f32 v32, v24, v25
v_cvt_pk_bf16_f32 v33, v26, v27
v_mfma_f32_32x32x16_bf16 v[208:223], v[68:71], v[60:63], v[208:223]
v_cvt_pk_bf16_f32 v34, v28, v29
v_cvt_pk_bf16_f32 v35, v30, v31
v_mfma_f32_32x32x16_bf16 v[160:175], v[232:235], v[224:227], v[160:175]
v_lshlrev_b32 v24, 16, v156
v_and_b32 v25, s50, v156
v_lshlrev_b32 v26, 16, v157
v_and_b32 v27, s50, v157
v_mfma_f32_32x32x16_bf16 v[192:207], v[232:235], v[228:231], v[192:207]
v_lshlrev_b32 v28, 16, v158
v_and_b32 v29, s50, v158
v_lshlrev_b32 v30, 16, v159
v_and_b32 v31, s50, v159
v_mfma_f32_32x32x16_bf16 v[176:191], v[236:239], v[224:227], v[176:191]
v_fma_f32 v24, v24, v19, v23
v_fma_f32 v25, v25, v19, v23
v_mfma_f32_32x32x16_bf16 v[208:223], v[236:239], v[228:231], v[208:223]
v_fma_f32 v26, v26, v19, v23
v_fma_f32 v27, v27, v19, v23
v_mfma_f32_32x32x16_bf16 v[160:175], v[248:251], v[240:243], v[160:175]
v_fma_f32 v28, v28, v19, v23
v_fma_f32 v29, v29, v19, v23
v_mfma_f32_32x32x16_bf16 v[192:207], v[248:251], v[244:247], v[192:207]
v_fma_f32 v30, v30, v19, v23
v_fma_f32 v31, v31, v19, v23
v_mfma_f32_32x32x16_bf16 v[176:191], v[252:255], v[240:243], v[176:191]
v_cvt_pk_bf16_f32 v36, v24, v25
v_cvt_pk_bf16_f32 v37, v26, v27
v_mfma_f32_32x32x16_bf16 v[208:223], v[252:255], v[244:247], v[208:223]
v_cvt_pk_bf16_f32 v38, v28, v29
v_cvt_pk_bf16_f32 v39, v30, v31
s_setprio 0
s_barrier
ds_read_b128 v[40:43], v10 offset:0
ds_read_b128 v[44:47], v10 offset:4096
ds_read_b64_tr_b16 v[48:49], v7 offset:0
ds_read_b64_tr_b16 v[50:51], v7 offset:2048
ds_read_b64_tr_b16 v[52:53], v9 offset:0
ds_read_b64_tr_b16 v[54:55], v9 offset:2048
ds_read_b128 v[56:59], v11 offset:0
ds_read_b128 v[60:63], v11 offset:4096
ds_read_b64_tr_b16 v[64:65], v7 offset:8192
ds_read_b64_tr_b16 v[66:67], v7 offset:10240
ds_read_b64_tr_b16 v[68:69], v9 offset:8192
ds_read_b64_tr_b16 v[70:71], v9 offset:10240
ds_read_b128 v[224:227], v12 offset:0
ds_read_b128 v[228:231], v12 offset:4096
ds_read_b64_tr_b16 v[232:233], v7 offset:16384
ds_read_b64_tr_b16 v[234:235], v7 offset:18432
ds_read_b64_tr_b16 v[236:237], v9 offset:16384
ds_read_b64_tr_b16 v[238:239], v9 offset:18432
ds_read_b128 v[240:243], v13 offset:0
ds_read_b128 v[244:247], v13 offset:4096
ds_read_b64_tr_b16 v[248:249], v7 offset:24576
ds_read_b64_tr_b16 v[250:251], v7 offset:26624
ds_read_b64_tr_b16 v[252:253], v9 offset:24576
ds_read_b64_tr_b16 v[254:255], v9 offset:26624
ds_write_b128 v14, v[32:35] offset:16384
ds_write_b128 v15, v[36:39] offset:16384
s_waitcnt vmcnt(0) lgkmcnt(0)
s_barrier
s_setprio 1
.p2align 3
v_mfma_f32_32x32x16_bf16 v[160:175], v[48:51], v[40:43], v[160:175]
v_add_u32 v109, 0, v1
v_mul_u32_u24 v110, 3277, v109
v_mfma_f32_32x32x16_bf16 v[192:207], v[48:51], v[44:47], v[192:207]
v_lshrrev_b32 v110, 16, v110
v_mul_u32_u24 v111, 20, v110
v_mfma_f32_32x32x16_bf16 v[176:191], v[52:55], v[40:43], v[176:191]
v_sub_u32 v111, v109, v111
v_mul_u32_u24 v110, 1280, v110
v_mfma_f32_32x32x16_bf16 v[208:223], v[52:55], v[44:47], v[208:223]
v_lshl_add_u32 v104, v111, 4, v110
v_add_u32 v109, 64, v1
v_mfma_f32_32x32x16_bf16 v[160:175], v[64:67], v[56:59], v[160:175]
v_mul_u32_u24 v110, 3277, v109
v_lshrrev_b32 v110, 16, v110
v_mfma_f32_32x32x16_bf16 v[192:207], v[64:67], v[60:63], v[192:207]
v_mul_u32_u24 v111, 20, v110
v_sub_u32 v111, v109, v111
v_mul_u32_u24 v110, 1280, v110
v_mfma_f32_32x32x16_bf16 v[176:191], v[68:71], v[56:59], v[176:191]
v_lshl_add_u32 v105, v111, 4, v110
v_add_u32 v109, 128, v1
v_mfma_f32_32x32x16_bf16 v[208:223], v[68:71], v[60:63], v[208:223]
v_mul_u32_u24 v110, 3277, v109
v_lshrrev_b32 v110, 16, v110
v_mfma_f32_32x32x16_bf16 v[160:175], v[232:235], v[224:227], v[160:175]
v_mul_u32_u24 v111, 20, v110
v_sub_u32 v111, v109, v111
v_mfma_f32_32x32x16_bf16 v[192:207], v[232:235], v[228:231], v[192:207]
v_mul_u32_u24 v110, 1280, v110
v_lshl_add_u32 v106, v111, 4, v110
v_mfma_f32_32x32x16_bf16 v[176:191], v[236:239], v[224:227], v[176:191]
v_add_u32 v109, 192, v1
v_mul_u32_u24 v110, 3277, v109
v_lshrrev_b32 v110, 16, v110
v_mfma_f32_32x32x16_bf16 v[208:223], v[236:239], v[228:231], v[208:223]
v_mul_u32_u24 v111, 20, v110
v_sub_u32 v111, v109, v111
v_mfma_f32_32x32x16_bf16 v[160:175], v[248:251], v[240:243], v[160:175]
v_mul_u32_u24 v110, 1280, v110
v_lshl_add_u32 v107, v111, 4, v110
v_mfma_f32_32x32x16_bf16 v[192:207], v[248:251], v[244:247], v[192:207]
v_add_u32 v109, 256, v1
v_mul_u32_u24 v110, 3277, v109
v_mfma_f32_32x32x16_bf16 v[176:191], v[252:255], v[240:243], v[176:191]
v_lshrrev_b32 v110, 16, v110
v_mul_u32_u24 v111, 20, v110
v_mfma_f32_32x32x16_bf16 v[208:223], v[252:255], v[244:247], v[208:223]
v_sub_u32 v111, v109, v111
v_mul_u32_u24 v110, 1280, v110
v_lshl_add_u32 v108, v111, 4, v110
s_setprio 0
s_barrier
ds_read_b128 v[40:43], v10 offset:16384
ds_read_b128 v[44:47], v10 offset:20480
ds_read_b64_tr_b16 v[48:49], v6 offset:0
ds_read_b64_tr_b16 v[50:51], v6 offset:2048
ds_read_b64_tr_b16 v[52:53], v8 offset:0
ds_read_b64_tr_b16 v[54:55], v8 offset:2048
ds_read_b128 v[56:59], v11 offset:16384
ds_read_b128 v[60:63], v11 offset:20480
ds_read_b64_tr_b16 v[64:65], v6 offset:8192
ds_read_b64_tr_b16 v[66:67], v6 offset:10240
ds_read_b64_tr_b16 v[68:69], v8 offset:8192
ds_read_b64_tr_b16 v[70:71], v8 offset:10240
ds_read_b128 v[224:227], v12 offset:16384
ds_read_b128 v[228:231], v12 offset:20480
ds_read_b64_tr_b16 v[232:233], v6 offset:16384
ds_read_b64_tr_b16 v[234:235], v6 offset:18432
ds_read_b64_tr_b16 v[236:237], v8 offset:16384
ds_read_b64_tr_b16 v[238:239], v8 offset:18432
ds_read_b128 v[240:243], v13 offset:16384
ds_read_b128 v[244:247], v13 offset:20480
ds_read_b64_tr_b16 v[248:249], v6 offset:24576
ds_read_b64_tr_b16 v[250:251], v6 offset:26624
ds_read_b64_tr_b16 v[252:253], v8 offset:24576
ds_read_b64_tr_b16 v[254:255], v8 offset:26624
ds_read_b64_tr_b16 v[80:81], v72 offset:0
ds_read_b64_tr_b16 v[82:83], v72 offset:160
ds_read_b64_tr_b16 v[84:85], v72 offset:320
ds_read_b64_tr_b16 v[86:87], v72 offset:480
ds_read_b64_tr_b16 v[88:89], v72 offset:640
ds_read_b64_tr_b16 v[92:93], v73 offset:32
ds_read_b64_tr_b16 v[94:95], v73 offset:192
ds_read_b64_tr_b16 v[96:97], v73 offset:352
ds_read_b64_tr_b16 v[98:99], v73 offset:512
ds_read_b64_tr_b16 v[100:101], v73 offset:672
s_cmp_eq_u32 s54, 0
s_cbranch_scc0 L_w3l_5
s_lshl_b32 s45, s38, 4
s_add_u32 s42, s45, s37
s_cmp_lt_u32 s42, 48
s_cselect_b32 s45, s32, s26
s_cselect_b32 s49, s33, s27
s_mov_b32 s52, 819200
s_cselect_b32 s52, 1966080, s52
s_mov_b32 s20, s45
s_and_b32 s21, s49, 0xffff
s_mov_b32 s22, s52
s_mov_b32 s23, 0x20000
s_sub_u32 s45, s42, 48
s_lshl_b32 s45, s45, 2
s_mul_i32 s45, s45, 43
s_lshr_b32 s52, s45, 7
s_mul_i32 s45, s52, 20
s_lshl_b32 s49, s42, 5
s_cmp_lt_u32 s42, 48
s_cselect_b32 s45, s49, s45
s_mul_i32 s53, s45, 1280
s_cmp_ge_u32 s42, 72
s_cselect_b32 s53, 0x7f000000, s53
s_mul_i32 s49, s55, 320
s_add_u32 s45, s53, s49
s_mul_i32 s49, s55, 13312
s_add_u32 s49, s49, 65536
s_add_u32 m0, s49, 0
s_add_u32 s52, s45, 0
buffer_load_dwordx4 v104, s[20:23], s52 offen lds
s_add_u32 m0, s49, 1024
s_add_u32 s52, s45, 0
buffer_load_dwordx4 v105, s[20:23], s52 offen lds
s_add_u32 m0, s49, 2048
s_add_u32 s52, s45, 0
buffer_load_dwordx4 v106, s[20:23], s52 offen lds
s_add_u32 m0, s49, 3072
s_add_u32 s52, s45, 0
buffer_load_dwordx4 v107, s[20:23], s52 offen lds
s_add_u32 m0, s49, 4096
s_add_u32 s52, s45, 0
buffer_load_dwordx4 v108, s[20:23], s52 offen lds
s_add_u32 m0, s49, 5120
s_add_u32 s52, s45, 20480
buffer_load_dwordx4 v104, s[20:23], s52 offen lds
s_add_u32 m0, s49, 6144
s_add_u32 s52, s45, 20480
buffer_load_dwordx4 v105, s[20:23], s52 offen lds
s_add_u32 m0, s49, 7168
s_add_u32 s52, s45, 20480
buffer_load_dwordx4 v106, s[20:23], s52 offen lds
s_add_u32 m0, s49, 8192
s_add_u32 s52, s45, 20480
buffer_load_dwordx4 v107, s[20:23], s52 offen lds
s_add_u32 m0, s49, 9216
s_add_u32 s52, s45, 20480
buffer_load_dwordx4 v108, s[20:23], s52 offen lds
s_add_u32 m0, s49, 10240
s_add_u32 s52, s45, 40960
buffer_load_dwordx4 v104, s[20:23], s52 offen lds
s_add_u32 m0, s49, 11264
s_add_u32 s52, s45, 40960
buffer_load_dwordx4 v105, s[20:23], s52 offen lds
s_add_u32 m0, s49, 12288
s_add_u32 s52, s45, 40960
buffer_load_dwordx4 v106, s[20:23], s52 offen lds
L_w3l_5:
s_waitcnt lgkmcnt(0)
s_barrier
s_setprio 1
.p2align 3
v_mfma_f32_32x32x16_bf16 v[160:175], v[48:51], v[40:43], v[160:175]
v_mfma_f32_32x32x16_bf16 v[192:207], v[48:51], v[44:47], v[192:207]
v_mfma_f32_32x32x16_bf16 v[176:191], v[52:55], v[40:43], v[176:191]
v_mfma_f32_32x32x16_bf16 v[208:223], v[52:55], v[44:47], v[208:223]
v_mfma_f32_32x32x16_bf16 v[160:175], v[64:67], v[56:59], v[160:175]
v_mfma_f32_32x32x16_bf16 v[192:207], v[64:67], v[60:63], v[192:207]
v_mfma_f32_32x32x16_bf16 v[176:191], v[68:71], v[56:59], v[176:191]
v_mfma_f32_32x32x16_bf16 v[208:223], v[68:71], v[60:63], v[208:223]
v_mov_b32 v90, 0
v_mov_b32 v91, 0
v_mfma_f32_32x32x16_bf16 v[160:175], v[232:235], v[224:227], v[160:175]
v_mfma_f32_32x32x16_bf16 v[192:207], v[232:235], v[228:231], v[192:207]
v_mfma_f32_32x32x16_bf16 v[176:191], v[236:239], v[224:227], v[176:191]
v_mfma_f32_32x32x16_bf16 v[208:223], v[236:239], v[228:231], v[208:223]
v_mfma_f32_32x32x16_bf16 v[160:175], v[248:251], v[240:243], v[160:175]
v_mfma_f32_32x32x16_bf16 v[192:207], v[248:251], v[244:247], v[192:207]
v_mfma_f32_32x32x16_bf16 v[176:191], v[252:255], v[240:243], v[176:191]
v_mfma_f32_32x32x16_bf16 v[208:223], v[252:255], v[244:247], v[208:223]
v_mov_b32 v102, 0
v_mov_b32 v103, 0
s_setprio 0
s_cmp_eq_u32 s54, 0
s_cbranch_scc0 L_g1_6
s_barrier
L_g1_6:
v_xor_b32 v24, 0, v75
v_add_u32 v16, v74, v24
v_xor_b32 v24, 16, v75
v_add_u32 v17, v74, v24
v_xor_b32 v24, 32, v75
v_add_u32 v18, v74, v24
v_xor_b32 v24, 48, v75
v_add_u32 v19, v74, v24
v_xor_b32 v24, 64, v75
v_add_u32 v20, v74, v24
v_lshrrev_b32 v25, 5, v1
v_add_u32 v24, 5, v25
v_lshlrev_b32 v24, 4, v24
v_xor_b32 v24, v24, v75
v_add_u32 v21, v74, v24
v_xor_b32 v24, 112, v75
v_add_u32 v24, v74, v24
v_lshl_add_u32 v22, v25, 3, v24
v_lshlrev_b32 v23, 4, v1
v_lshlrev_b32 v78, 3, v1
v_lshlrev_b32 v24, 12, v25
v_add_u32 v16, v16, v24
v_add_u32 v17, v17, v24
v_add_u32 v18, v18, v24
v_add_u32 v19, v19, v24
v_add_u32 v20, v20, v24
s_lshl_b32 s45, s37, 1
s_add_u32 s45, s45, s54
s_lshl_b32 s45, s45, 5
s_lshl_b32 s49, s38, 2
s_add_u32 s45, s45, s49
s_add_u32 s45, s45, s55
s_mul_i32 s45, s45, 2560
s_add_u32 s57, s45, 9437184
v_mov_b32 v79, 1069066811
v_cvt_pk_bf16_f32 v104, v160, v161
v_cvt_pk_bf16_f32 v105, v162, v163
v_cvt_pk_bf16_f32 v106, v164, v165
v_cvt_pk_bf16_f32 v107, v166, v167
v_cvt_pk_bf16_f32 v108, v168, v169
v_cvt_pk_bf16_f32 v109, v170, v171
v_cvt_pk_bf16_f32 v110, v172, v173
v_cvt_pk_bf16_f32 v111, v174, v175
v_cvt_pk_bf16_f32 v112, v176, v177
v_cvt_pk_bf16_f32 v113, v178, v179
v_mov_b32 v114, 0
v_mov_b32 v115, 0
v_cvt_pk_bf16_f32 v128, v180, v181
v_cvt_pk_bf16_f32 v129, v182, v183
v_cvt_pk_bf16_f32 v130, v184, v185
v_cvt_pk_bf16_f32 v131, v186, v187
v_cvt_pk_bf16_f32 v132, v188, v189
v_cvt_pk_bf16_f32 v133, v190, v191
s_mov_b32 exec_lo, 0
v_mov_b32 v132, 0x3f80
v_mov_b32 v133, 0
s_mov_b32 exec_lo, -1
v_mfma_f32_32x32x16_bf16 v[160:175], v[80:83], v[104:107], 0
v_mfma_f32_32x32x16_bf16 v[160:175], v[84:87], v[108:111], v[160:175]
v_mfma_f32_32x32x16_bf16 v[160:175], v[88:91], v[112:115], v[160:175]
v_mfma_f32_32x32x16_bf16 v[176:191], v[92:95], v[104:107], 0
v_mfma_f32_32x32x16_bf16 v[176:191], v[96:99], v[108:111], v[176:191]
v_mfma_f32_32x32x16_bf16 v[176:191], v[100:103], v[112:115], v[176:191]
ds_write_b128 v21, v[128:131] offset:0
ds_write_b64 v22, v[132:133] offset:0
v_cvt_pk_bf16_f32 v116, v192, v193
v_cvt_pk_bf16_f32 v117, v194, v195
v_cvt_pk_bf16_f32 v118, v196, v197
v_cvt_pk_bf16_f32 v119, v198, v199
v_cvt_pk_bf16_f32 v120, v200, v201
v_cvt_pk_bf16_f32 v121, v202, v203
v_cvt_pk_bf16_f32 v122, v204, v205
v_cvt_pk_bf16_f32 v123, v206, v207
v_cvt_pk_bf16_f32 v124, v208, v209
v_cvt_pk_bf16_f32 v125, v210, v211
v_mov_b32 v126, 0
v_mov_b32 v127, 0
v_cvt_pk_bf16_f32 v134, v212, v213
v_cvt_pk_bf16_f32 v135, v214, v215
v_cvt_pk_bf16_f32 v136, v216, v217
v_cvt_pk_bf16_f32 v137, v218, v219
v_cvt_pk_bf16_f32 v138, v220, v221
v_cvt_pk_bf16_f32 v139, v222, v223
s_mov_b32 exec_lo, 0
v_mov_b32 v138, 0x3f80
v_mov_b32 v139, 0
s_mov_b32 exec_lo, -1
v_mfma_f32_32x32x16_bf16 v[192:207], v[80:83], v[116:119], 0
v_mfma_f32_32x32x16_bf16 v[192:207], v[84:87], v[120:123], v[192:207]
v_mfma_f32_32x32x16_bf16 v[192:207], v[88:91], v[124:127], v[192:207]
v_mfma_f32_32x32x16_bf16 v[208:223], v[92:95], v[116:119], 0
v_mfma_f32_32x32x16_bf16 v[208:223], v[96:99], v[120:123], v[208:223]
v_mfma_f32_32x32x16_bf16 v[208:223], v[100:103], v[124:127], v[208:223]
ds_write_b128 v21, v[134:137] offset:4096
ds_write_b64 v22, v[138:139] offset:4096
s_nop 7
s_nop 3
v_permlane32_swap_b32 v160, v192
v_permlane32_swap_b32 v161, v193
v_permlane32_swap_b32 v162, v194
v_permlane32_swap_b32 v163, v195
v_permlane32_swap_b32 v164, v196
v_permlane32_swap_b32 v165, v197
v_permlane32_swap_b32 v166, v198
v_permlane32_swap_b32 v167, v199
v_permlane32_swap_b32 v168, v200
v_permlane32_swap_b32 v169, v201
v_permlane32_swap_b32 v170, v202
v_permlane32_swap_b32 v171, v203
v_permlane32_swap_b32 v172, v204
v_permlane32_swap_b32 v173, v205
v_permlane32_swap_b32 v174, v206
v_permlane32_swap_b32 v175, v207
v_permlane32_swap_b32 v176, v208
v_permlane32_swap_b32 v177, v209
v_permlane32_swap_b32 v178, v210
v_permlane32_swap_b32 v179, v211
s_nop 1
v_cvt_pk_bf16_f32 v104, v160, v161
v_cvt_pk_bf16_f32 v105, v162, v163
v_cvt_pk_bf16_f32 v106, v164, v165
v_cvt_pk_bf16_f32 v107, v166, v167
v_cvt_pk_bf16_f32 v108, v168, v169
v_cvt_pk_bf16_f32 v109, v170, v171
v_cvt_pk_bf16_f32 v110, v172, v173
v_cvt_pk_bf16_f32 v111, v174, v175
v_cvt_pk_bf16_f32 v112, v176, v177
v_cvt_pk_bf16_f32 v113, v178, v179
buffer_store_dwordx4 v[104:107], v23, s[16:19], s57 offen sc0 sc1
buffer_store_dwordx4 v[108:111], v23, s[16:19], s57 offen offset:1024 sc0 sc1
buffer_store_dwordx2 v[112:113], v78, s[16:19], s57 offen offset:2048 sc0 sc1
v_max3_f32 v24, v192, v193, v194
v_min3_f32 v25, v192, v193, v194
v_max3_f32 v26, v195, v196, v197
v_min3_f32 v27, v195, v196, v197
v_max3_f32 v24, v24, v198, v199
v_min3_f32 v25, v25, v198, v199
v_max3_f32 v26, v26, v200, v201
v_min3_f32 v27, v27, v200, v201
v_max3_f32 v24, v24, v202, v203
v_min3_f32 v25, v25, v202, v203
v_max3_f32 v26, v26, v204, v205
v_min3_f32 v27, v27, v204, v205
v_max3_f32 v24, v24, v206, v207
v_min3_f32 v25, v25, v206, v207
v_max3_f32 v26, v26, v208, v209
v_min3_f32 v27, v27, v208, v209
v_max3_f32 v24, v24, v210, v211
v_min3_f32 v25, v25, v210, v211
v_max_f32 v24, v24, v26
v_min_f32 v25, v25, v27
v_mul_f32 v24, v79, v24
v_mul_f32 v25, v79, v25
v_fma_f32 v224, v192, v79, -v24
v_fma_f32 v40, -v192, v79, v25
v_fma_f32 v225, v193, v79, -v24
v_fma_f32 v41, -v193, v79, v25
v_fma_f32 v226, v194, v79, -v24
v_fma_f32 v42, -v194, v79, v25
v_fma_f32 v227, v195, v79, -v24
v_fma_f32 v43, -v195, v79, v25
v_fma_f32 v228, v196, v79, -v24
v_fma_f32 v44, -v196, v79, v25
v_fma_f32 v229, v197, v79, -v24
v_fma_f32 v45, -v197, v79, v25
v_fma_f32 v230, v198, v79, -v24
v_fma_f32 v46, -v198, v79, v25
v_fma_f32 v231, v199, v79, -v24
v_fma_f32 v47, -v199, v79, v25
v_fma_f32 v232, v200, v79, -v24
v_fma_f32 v48, -v200, v79, v25
v_fma_f32 v233, v201, v79, -v24
v_fma_f32 v49, -v201, v79, v25
v_fma_f32 v234, v202, v79, -v24
v_fma_f32 v50, -v202, v79, v25
v_fma_f32 v235, v203, v79, -v24
v_fma_f32 v51, -v203, v79, v25
v_fma_f32 v236, v204, v79, -v24
v_fma_f32 v52, -v204, v79, v25
v_fma_f32 v237, v205, v79, -v24
v_fma_f32 v53, -v205, v79, v25
v_fma_f32 v238, v206, v79, -v24
v_fma_f32 v54, -v206, v79, v25
v_fma_f32 v239, v207, v79, -v24
v_fma_f32 v55, -v207, v79, v25
v_fma_f32 v240, v208, v79, -v24
v_fma_f32 v56, -v208, v79, v25
v_fma_f32 v241, v209, v79, -v24
v_fma_f32 v57, -v209, v79, v25
v_fma_f32 v242, v210, v79, -v24
v_fma_f32 v58, -v210, v79, v25
v_fma_f32 v243, v211, v79, -v24
v_fma_f32 v59, -v211, v79, v25
v_exp_f32 v224, v224
v_exp_f32 v40, v40
v_exp_f32 v225, v225
v_exp_f32 v41, v41
v_exp_f32 v226, v226
v_exp_f32 v42, v42
v_exp_f32 v227, v227
v_exp_f32 v43, v43
v_exp_f32 v228, v228
v_exp_f32 v44, v44
v_exp_f32 v229, v229
v_exp_f32 v45, v45
v_exp_f32 v230, v230
v_exp_f32 v46, v46
v_exp_f32 v231, v231
v_exp_f32 v47, v47
v_exp_f32 v232, v232
v_exp_f32 v48, v48
v_exp_f32 v233, v233
v_exp_f32 v49, v49
v_exp_f32 v234, v234
v_exp_f32 v50, v50
v_exp_f32 v235, v235
v_exp_f32 v51, v51
v_exp_f32 v236, v236
v_exp_f32 v52, v52
v_exp_f32 v237, v237
v_exp_f32 v53, v53
v_exp_f32 v238, v238
v_exp_f32 v54, v54
v_exp_f32 v239, v239
v_exp_f32 v55, v55
v_exp_f32 v240, v240
v_exp_f32 v56, v56
v_exp_f32 v241, v241
v_exp_f32 v57, v57
v_exp_f32 v242, v242
v_exp_f32 v58, v58
v_exp_f32 v243, v243
v_exp_f32 v59, v59
v_pk_add_f32 v[26:27], v[224:225], v[226:227]
v_pk_add_f32 v[28:29], v[40:41], v[42:43]
v_pk_add_f32 v[26:27], v[26:27], v[228:229]
v_pk_add_f32 v[28:29], v[28:29], v[44:45]
v_pk_add_f32 v[26:27], v[26:27], v[230:231]
v_pk_add_f32 v[28:29], v[28:29], v[46:47]
v_pk_add_f32 v[26:27], v[26:27], v[232:233]
v_pk_add_f32 v[28:29], v[28:29], v[48:49]
v_pk_add_f32 v[26:27], v[26:27], v[234:235]
v_pk_add_f32 v[28:29], v[28:29], v[50:51]
v_pk_add_f32 v[26:27], v[26:27], v[236:237]
v_pk_add_f32 v[28:29], v[28:29], v[52:53]
v_pk_add_f32 v[26:27], v[26:27], v[238:239]
v_pk_add_f32 v[28:29], v[28:29], v[54:55]
v_pk_add_f32 v[26:27], v[26:27], v[240:241]
v_pk_add_f32 v[28:29], v[28:29], v[56:57]
v_pk_add_f32 v[26:27], v[26:27], v[242:243]
v_pk_add_f32 v[28:29], v[28:29], v[58:59]
v_add_f32 v26, v26, v27
v_add_f32 v28, v28, v29
v_rcp_f32 v26, v26
v_rcp_f32 v28, v28
s_nop 0
v_pk_mul_f32 v[224:225], v[224:225], v[26:27] op_sel_hi:[1,0]
v_pk_mul_f32 v[40:41], v[40:41], v[28:29] op_sel_hi:[1,0]
v_pk_mul_f32 v[226:227], v[226:227], v[26:27] op_sel_hi:[1,0]
v_pk_mul_f32 v[42:43], v[42:43], v[28:29] op_sel_hi:[1,0]
v_pk_mul_f32 v[228:229], v[228:229], v[26:27] op_sel_hi:[1,0]
v_pk_mul_f32 v[44:45], v[44:45], v[28:29] op_sel_hi:[1,0]
v_pk_mul_f32 v[230:231], v[230:231], v[26:27] op_sel_hi:[1,0]
v_pk_mul_f32 v[46:47], v[46:47], v[28:29] op_sel_hi:[1,0]
v_pk_mul_f32 v[232:233], v[232:233], v[26:27] op_sel_hi:[1,0]
v_pk_mul_f32 v[48:49], v[48:49], v[28:29] op_sel_hi:[1,0]
v_pk_mul_f32 v[234:235], v[234:235], v[26:27] op_sel_hi:[1,0]
v_pk_mul_f32 v[50:51], v[50:51], v[28:29] op_sel_hi:[1,0]
v_pk_mul_f32 v[236:237], v[236:237], v[26:27] op_sel_hi:[1,0]
v_pk_mul_f32 v[52:53], v[52:53], v[28:29] op_sel_hi:[1,0]
v_pk_mul_f32 v[238:239], v[238:239], v[26:27] op_sel_hi:[1,0]
v_pk_mul_f32 v[54:55], v[54:55], v[28:29] op_sel_hi:[1,0]
v_pk_mul_f32 v[240:241], v[240:241], v[26:27] op_sel_hi:[1,0]
v_pk_mul_f32 v[56:57], v[56:57], v[28:29] op_sel_hi:[1,0]
v_pk_mul_f32 v[242:243], v[242:243], v[26:27] op_sel_hi:[1,0]
v_pk_mul_f32 v[58:59], v[58:59], v[28:29] op_sel_hi:[1,0]
v_cvt_pk_bf16_f32 v140, v224, v225
v_cvt_pk_bf16_f32 v141, v226, v227
v_cvt_pk_bf16_f32 v142, v228, v229
v_cvt_pk_bf16_f32 v143, v230, v231
v_cvt_pk_bf16_f32 v144, v232, v233
v_cvt_pk_bf16_f32 v145, v234, v235
v_cvt_pk_bf16_f32 v146, v236, v237
v_cvt_pk_bf16_f32 v147, v238, v239
v_cvt_pk_bf16_f32 v148, v240, v241
v_cvt_pk_bf16_f32 v149, v242, v243
v_cvt_pk_bf16_f32 v150, v40, v41
v_cvt_pk_bf16_f32 v151, v42, v43
v_cvt_pk_bf16_f32 v152, v44, v45
v_cvt_pk_bf16_f32 v153, v46, v47
v_cvt_pk_bf16_f32 v154, v48, v49
v_cvt_pk_bf16_f32 v155, v50, v51
v_cvt_pk_bf16_f32 v156, v52, v53
v_cvt_pk_bf16_f32 v157, v54, v55
v_cvt_pk_bf16_f32 v158, v56, v57
v_cvt_pk_bf16_f32 v159, v58, v59
ds_write_b128 v16, v[140:143]
ds_write_b128 v17, v[144:147]
ds_write_b128 v18, v[148:151]
ds_write_b128 v19, v[152:155]
ds_write_b128 v20, v[156:159]
s_waitcnt vmcnt(3)
s_cmp_eq_u32 s54, 0
s_cbranch_scc0 L_w3r_7
s_lshl_b32 s45, s38, 4
s_add_u32 s42, s45, s37
s_cmp_ge_u32 s42, 72
s_cbranch_scc1 L_w3r_7
v_lshrrev_b32 v24, 4, v1
v_bfe_u32 v25, v1, 2, 2
v_lshrrev_b32 v26, 1, v24
v_lshlrev_b32 v26, 4, v26
v_and_b32 v27, 1, v24
v_lshl_add_u32 v26, v27, 2, v26
v_add_u32 v27, 8, v26
s_sub_u32 s45, s42, 48
s_lshl_b32 s45, s45, 2
s_mul_i32 s49, s45, 43
s_lshr_b32 s49, s49, 7
v_add_u32 v28, s45, v24
v_mul_u32_u24 v29, 43, v28
v_lshrrev_b32 v29, 7, v29
v_mul_u32_u24 v30, 3, v29
v_sub_u32 v28, v28, v30
v_subrev_u32 v29, s49, v29
v_mul_u32_u24 v29, 20, v29
v_lshlrev_b32 v30, 2, v28
v_cmp_eq_u32 vcc, 2, v28
v_mov_b32 v31, 16
s_nop 0
v_cndmask_b32 v30, v30, v31, vcc
v_add_u32 v30, v29, v30
v_add_u32 v31, 8, v30
s_mov_b64 s[58:59], vcc
s_cmp_lt_u32 s42, 48
s_cselect_b64 vcc, -1, 0
s_cselect_b64 s[58:59], 0, s[58:59]
v_cndmask_b32 v26, v30, v26, vcc
v_cndmask_b32 v27, v31, v27, vcc
v_and_b32 v28, 3, v1
v_lshlrev_b32 v28, 3, v28
s_mul_i32 s45, s55, 13312
s_add_u32 s45, s45, 65536
v_add_u32 v26, v26, v25
v_mul_u32_u24 v26, 320, v26
v_add_u32 v26, v26, v28
v_add_u32 v26, s45, v26
v_add_u32 v27, v27, v25
v_mul_u32_u24 v27, 320, v27
v_add_u32 v27, v27, v28
v_add_u32 v27, s45, v27
v_mov_b32 v29, 135168
s_nop 0
v_cndmask_b32 v27, v27, v29, s[58:59]
ds_read_b64_tr_b16 v[80:81], v26 offset:0
ds_read_b64_tr_b16 v[82:83], v27 offset:0
ds_read_b64_tr_b16 v[84:85], v26 offset:32
ds_read_b64_tr_b16 v[86:87], v27 offset:32
ds_read_b64_tr_b16 v[88:89], v26 offset:64
ds_read_b64_tr_b16 v[90:91], v27 offset:64
ds_read_b64_tr_b16 v[92:93], v26 offset:96
ds_read_b64_tr_b16 v[94:95], v27 offset:96
ds_read_b64_tr_b16 v[96:97], v26 offset:128
ds_read_b64_tr_b16 v[98:99], v27 offset:128
ds_read_b64_tr_b16 v[100:101], v26 offset:160
ds_read_b64_tr_b16 v[102:103], v27 offset:160
ds_read_b64_tr_b16 v[104:105], v26 offset:192
ds_read_b64_tr_b16 v[106:107], v27 offset:192
ds_read_b64_tr_b16 v[108:109], v26 offset:224
ds_read_b64_tr_b16 v[110:111], v27 offset:224
ds_read_b64_tr_b16 v[112:113], v26 offset:256
ds_read_b64_tr_b16 v[114:115], v27 offset:256
ds_read_b64_tr_b16 v[116:117], v26 offset:288
ds_read_b64_tr_b16 v[118:119], v27 offset:288
s_mul_i32 s45, s55, 144
s_add_u32 s45, s45, s42
s_mul_i32 s45, s45, 5120
s_add_u32 s45, s45, 17301504
v_lshlrev_b32 v24, 4, v1
s_waitcnt lgkmcnt(10)
s_add_u32 s49, s45, 0
buffer_store_dwordx4 v[80:83], v24, s[16:19], s49 offen sc0 sc1
s_add_u32 s49, s45, 1024
buffer_store_dwordx4 v[84:87], v24, s[16:19], s49 offen sc0 sc1
s_add_u32 s49, s45, 2048
buffer_store_dwordx4 v[88:91], v24, s[16:19], s49 offen sc0 sc1
s_add_u32 s49, s45, 3072
buffer_store_dwordx4 v[92:95], v24, s[16:19], s49 offen sc0 sc1
s_add_u32 s49, s45, 4096
buffer_store_dwordx4 v[96:99], v24, s[16:19], s49 offen sc0 sc1
s_waitcnt lgkmcnt(0)
s_add_u32 s49, s45, 368640
buffer_store_dwordx4 v[100:103], v24, s[16:19], s49 offen sc0 sc1
s_add_u32 s49, s45, 369664
buffer_store_dwordx4 v[104:107], v24, s[16:19], s49 offen sc0 sc1
s_add_u32 s49, s45, 370688
buffer_store_dwordx4 v[108:111], v24, s[16:19], s49 offen sc0 sc1
s_add_u32 s49, s45, 371712
buffer_store_dwordx4 v[112:115], v24, s[16:19], s49 offen sc0 sc1
s_add_u32 s49, s45, 372736
buffer_store_dwordx4 v[116:119], v24, s[16:19], s49 offen sc0 sc1
L_w3r_7:
s_waitcnt lgkmcnt(0)
s_barrier
v_xor_b32 v24, 32, v76
v_add_u32 v24, 512, v24
v_xor_b32 v25, 32, v77
v_add_u32 v25, 512, v25
ds_read_b64_tr_b16 v[80:81], v76 offset:0
ds_read_b64_tr_b16 v[82:83], v24 offset:0
ds_read_b64_tr_b16 v[84:85], v77 offset:0
ds_read_b64_tr_b16 v[86:87], v25 offset:0
ds_read_b64_tr_b16 v[88:89], v76 offset:2048
ds_read_b64_tr_b16 v[90:91], v24 offset:2048
ds_read_b64_tr_b16 v[92:93], v77 offset:2048
ds_read_b64_tr_b16 v[94:95], v25 offset:2048
ds_read_b64_tr_b16 v[96:97], v76 offset:4096
ds_read_b64_tr_b16 v[98:99], v24 offset:4096
ds_read_b64_tr_b16 v[100:101], v77 offset:4096
ds_read_b64_tr_b16 v[102:103], v25 offset:4096
s_lshl_b32 s45, s37, 5
s_lshl_b32 s49, s38, 2
s_add_u32 s45, s45, s49
s_add_u32 s45, s45, s55
s_mul_i32 s45, s45, 5120
s_lshl_b32 s49, s54, 12
s_add_u32 s45, s45, s49
s_add_u32 s45, s45, 14680064
ds_read_b64_tr_b16 v[104:105], v76 offset:6144
ds_read_b64_tr_b16 v[106:107], v24 offset:6144
ds_read_b64_tr_b16 v[108:109], v77 offset:6144
ds_read_b64_tr_b16 v[110:111], v25 offset:6144
ds_read_b64_tr_b16 v[112:113], v76 offset:8192
ds_read_b64_tr_b16 v[114:115], v24 offset:8192
ds_read_b64_tr_b16 v[116:117], v77 offset:8192
ds_read_b64_tr_b16 v[118:119], v25 offset:8192
ds_read_b64_tr_b16 v[120:121], v76 offset:10240
ds_read_b64_tr_b16 v[122:123], v24 offset:10240
ds_read_b64_tr_b16 v[124:125], v77 offset:10240
ds_read_b64_tr_b16 v[126:127], v25 offset:10240
ds_read_b64_tr_b16 v[128:129], v76 offset:12288
ds_read_b64_tr_b16 v[130:131], v24 offset:12288
ds_read_b64_tr_b16 v[132:133], v77 offset:12288
ds_read_b64_tr_b16 v[134:135], v25 offset:12288
ds_read_b64_tr_b16 v[136:137], v76 offset:14336
ds_read_b64_tr_b16 v[138:139], v24 offset:14336
ds_read_b64_tr_b16 v[140:141], v77 offset:14336
ds_read_b64_tr_b16 v[142:143], v25 offset:14336
s_waitcnt lgkmcnt(15)
v_mfma_f32_32x32x16_bf16 v[224:239], v[80:83], v[84:87], 0
s_waitcnt lgkmcnt(15)
v_mfma_f32_32x32x16_bf16 v[224:239], v[88:91], v[92:95], v[224:239]
s_waitcnt lgkmcnt(15)
v_mfma_f32_32x32x16_bf16 v[224:239], v[96:99], v[100:103], v[224:239]
s_waitcnt lgkmcnt(15)
v_mfma_f32_32x32x16_bf16 v[224:239], v[104:107], v[108:111], v[224:239]
s_waitcnt lgkmcnt(12)
v_mfma_f32_32x32x16_bf16 v[224:239], v[112:115], v[116:119], v[224:239]
s_waitcnt lgkmcnt(8)
v_mfma_f32_32x32x16_bf16 v[224:239], v[120:123], v[124:127], v[224:239]
s_waitcnt lgkmcnt(4)
v_mfma_f32_32x32x16_bf16 v[224:239], v[128:131], v[132:135], v[224:239]
s_waitcnt lgkmcnt(0)
v_mfma_f32_32x32x16_bf16 v[224:239], v[136:139], v[140:143], v[224:239]
v_lshlrev_b32 v26, 4, v1
v_and_b32 v27, 31, v1
v_cmp_gt_u32 vcc, 21, v27
s_nop 7
s_nop 1
s_and_saveexec_b64 s[58:59], vcc
buffer_store_dwordx4 v[224:227], v26, s[16:19], s45 offen sc0 sc1
s_cmp_eq_u32 s54, 0
s_cbranch_scc0 L_kvskip_8
buffer_store_dwordx4 v[228:231], v26, s[16:19], s45 offen offset:1024 sc0 sc1
buffer_store_dwordx4 v[232:235], v26, s[16:19], s45 offen offset:2048 sc0 sc1
buffer_store_dwordx4 v[236:239], v26, s[16:19], s45 offen offset:3072 sc0 sc1
L_kvskip_8:
s_mov_b64 exec, s[58:59]
s_endpgm
L_k1_end:
.globl k3_kernel
.p2align 8
.type k3_kernel,@function
k3_kernel:
s_cmp_ge_u32 s2, 256
s_cbranch_scc0 L_k3_go
s_endpgm
L_k3_go:
s_load_dwordx2 s[4:5], s[0:1], 80
s_load_dwordx2 s[6:7], s[0:1], 0
s_load_dwordx2 s[28:29], s[0:1], 64
v_and_b32 v1, 63, v0
v_lshrrev_b32 v2, 6, v0
s_and_b32 s32, s2, 7
v_readfirstlane_b32 s20, v2
s_lshr_b32 s33, s2, 3
s_lshr_b32 s34, s32, 1
s_lshl_b32 s34, s34, 3
s_and_b32 s35, s33, 7
s_add_u32 s21, s34, s35
s_and_b32 s34, s32, 1
s_lshl_b32 s34, s34, 2
s_lshr_b32 s36, s33, 3
s_add_u32 s22, s34, s36
v_lshlrev_b32 v3, 4, v1
v_add_u32 v9, 4096, v3
v_mov_b32 v2, 163824
s_and_b32 s25, s20, 3
s_cmp_ge_u32 s20, 4
s_cbranch_scc1 L_k3_owave
s_mul_i32 s37, s25, 11
s_mul_i32 s40, s21, 48
s_add_u32 s40, s40, s37
s_lshl_b32 s40, s40, 12
s_mul_i32 s41, s22, 72
s_add_u32 s41, s41, s37
s_mul_i32 s41, s41, 5120
s_add_u32 s41, s41, 17301504
s_waitcnt lgkmcnt(0)
s_mov_b32 s8, s4
s_and_b32 s9, s5, 0xffff
s_mov_b32 s10, 33554432
s_mov_b32 s11, 0x20000
buffer_load_dwordx4 v[32:35], v3, s[8:11], s40 offen offset:0
buffer_load_dwordx4 v[36:39], v3, s[8:11], s40 offen offset:1024
buffer_load_dwordx4 v[40:43], v3, s[8:11], s40 offen offset:2048
buffer_load_dwordx4 v[44:47], v3, s[8:11], s40 offen offset:3072
s_add_u32 s40, s40, 4096
buffer_load_dwordx4 v[48:51], v3, s[8:11], s41 offen offset:0
buffer_load_dwordx4 v[52:55], v3, s[8:11], s41 offen offset:1024
buffer_load_dwordx4 v[56:59], v3, s[8:11], s41 offen offset:2048
buffer_load_dwordx4 v[60:63], v3, s[8:11], s41 offen offset:3072
buffer_load_dwordx4 v[64:67], v9, s[8:11], s41 offen
s_add_u32 s41, s41, 5120
s_barrier
buffer_load_dwordx4 v[68:71], v3, s[8:11], s40 offen offset:0
buffer_load_dwordx4 v[72:75], v3, s[8:11], s40 offen offset:1024
buffer_load_dwordx4 v[76:79], v3, s[8:11], s40 offen offset:2048
buffer_load_dwordx4 v[80:83], v3, s[8:11], s40 offen offset:3072
s_add_u32 s40, s40, 4096
buffer_load_dwordx4 v[84:87], v3, s[8:11], s41 offen offset:0
buffer_load_dwordx4 v[88:91], v3, s[8:11], s41 offen offset:1024
buffer_load_dwordx4 v[92:95], v3, s[8:11], s41 offen offset:2048
buffer_load_dwordx4 v[96:99], v3, s[8:11], s41 offen offset:3072
buffer_load_dwordx4 v[100:103], v9, s[8:11], s41 offen
s_add_u32 s41, s41, 5120
s_mov_b32 s12, s6
s_and_b32 s13, s7, 0xffff
s_mov_b32 s14, 2621440
s_mov_b32 s15, 0x20000
v_mul_u32_u24 v18, 6554, v0
v_lshrrev_b32 v18, 16, v18
v_mul_u32_u24 v19, 10, v18
v_sub_u32 v19, v0, v19
v_mul_u32_u24 v28, 1280, v18
v_lshl_add_u32 v28, v19, 4, v28
v_add_u32 v16, 512, v0
v_mul_u32_u24 v17, 6554, v16
v_lshrrev_b32 v17, 16, v17
v_mul_u32_u24 v29, 10, v17
v_sub_u32 v16, v16, v29
v_mul_u32_u24 v29, 1280, v17
v_lshl_add_u32 v29, v16, 4, v29
s_mul_i32 s26, s21, 81920
s_mul_i32 s34, s22, 160
s_add_u32 s26, s26, s34
buffer_load_dwordx4 v[20:23], v28, s[12:15], s26 offen
s_cmp_lt_u32 s20, 2
s_cbranch_scc0 L_x2_9
buffer_load_dwordx4 v[24:27], v29, s[12:15], s26 offen
L_x2_9:
s_waitcnt vmcnt(10)
v_mfma_f32_16x16x32_bf16 v[176:179], v[48:51], v[32:35], 0
v_mfma_f32_16x16x32_bf16 v[180:183], v[48:51], v[36:39], 0
buffer_load_dwordx4 v[104:107], v3, s[8:11], s40 offen offset:0
v_mfma_f32_16x16x32_bf16 v[184:187], v[48:51], v[40:43], 0
v_mfma_f32_16x16x32_bf16 v[188:191], v[48:51], v[44:47], 0
buffer_load_dwordx4 v[108:111], v3, s[8:11], s40 offen offset:1024
v_mfma_f32_16x16x32_bf16 v[192:195], v[52:55], v[32:35], 0
v_mfma_f32_16x16x32_bf16 v[196:199], v[52:55], v[36:39], 0
buffer_load_dwordx4 v[112:115], v3, s[8:11], s40 offen offset:2048
v_mfma_f32_16x16x32_bf16 v[200:203], v[52:55], v[40:43], 0
v_mfma_f32_16x16x32_bf16 v[204:207], v[52:55], v[44:47], 0
buffer_load_dwordx4 v[116:119], v3, s[8:11], s40 offen offset:3072
v_mfma_f32_16x16x32_bf16 v[208:211], v[56:59], v[32:35], 0
v_mfma_f32_16x16x32_bf16 v[212:215], v[56:59], v[36:39], 0
s_add_u32 s40, s40, 4096
v_mfma_f32_16x16x32_bf16 v[216:219], v[56:59], v[40:43], 0
buffer_load_dwordx4 v[120:123], v3, s[8:11], s41 offen offset:0
v_mfma_f32_16x16x32_bf16 v[220:223], v[56:59], v[44:47], 0
v_mfma_f32_16x16x32_bf16 v[224:227], v[60:63], v[32:35], 0
buffer_load_dwordx4 v[124:127], v3, s[8:11], s41 offen offset:1024
v_mfma_f32_16x16x32_bf16 v[228:231], v[60:63], v[36:39], 0
v_mfma_f32_16x16x32_bf16 v[232:235], v[60:63], v[40:43], 0
buffer_load_dwordx4 v[128:131], v3, s[8:11], s41 offen offset:2048
v_mfma_f32_16x16x32_bf16 v[236:239], v[60:63], v[44:47], 0
v_mfma_f32_16x16x32_bf16 v[240:243], v[64:67], v[32:35], 0
buffer_load_dwordx4 v[132:135], v3, s[8:11], s41 offen offset:3072
v_mfma_f32_16x16x32_bf16 v[244:247], v[64:67], v[36:39], 0
v_mfma_f32_16x16x32_bf16 v[248:251], v[64:67], v[40:43], 0
buffer_load_dwordx4 v[136:139], v9, s[8:11], s41 offen
v_mfma_f32_16x16x32_bf16 v[252:255], v[64:67], v[44:47], 0
s_add_u32 s41, s41, 5120
s_waitcnt vmcnt(10)
v_mfma_f32_16x16x32_bf16 v[176:179], v[84:87], v[68:71], v[176:179]
v_mfma_f32_16x16x32_bf16 v[180:183], v[84:87], v[72:75], v[180:183]
buffer_load_dwordx4 v[140:143], v3, s[8:11], s40 offen offset:0
v_mfma_f32_16x16x32_bf16 v[184:187], v[84:87], v[76:79], v[184:187]
v_mfma_f32_16x16x32_bf16 v[188:191], v[84:87], v[80:83], v[188:191]
buffer_load_dwordx4 v[144:147], v3, s[8:11], s40 offen offset:1024
v_mfma_f32_16x16x32_bf16 v[192:195], v[88:91], v[68:71], v[192:195]
v_mfma_f32_16x16x32_bf16 v[196:199], v[88:91], v[72:75], v[196:199]
buffer_load_dwordx4 v[148:151], v3, s[8:11], s40 offen offset:2048
v_mfma_f32_16x16x32_bf16 v[200:203], v[88:91], v[76:79], v[200:203]
v_mfma_f32_16x16x32_bf16 v[204:207], v[88:91], v[80:83], v[204:207]
buffer_load_dwordx4 v[152:155], v3, s[8:11], s40 offen offset:3072
v_mfma_f32_16x16x32_bf16 v[208:211], v[92:95], v[68:71], v[208:211]
v_mfma_f32_16x16x32_bf16 v[212:215], v[92:95], v[72:75], v[212:215]
s_add_u32 s40, s40, 4096
v_mfma_f32_16x16x32_bf16 v[216:219], v[92:95], v[76:79], v[216:219]
buffer_load_dwordx4 v[156:159], v3, s[8:11], s41 offen offset:0
v_mfma_f32_16x16x32_bf16 v[220:223], v[92:95], v[80:83], v[220:223]
v_mfma_f32_16x16x32_bf16 v[224:227], v[96:99], v[68:71], v[224:227]
buffer_load_dwordx4 v[160:163], v3, s[8:11], s41 offen offset:1024
v_mfma_f32_16x16x32_bf16 v[228:231], v[96:99], v[72:75], v[228:231]
v_mfma_f32_16x16x32_bf16 v[232:235], v[96:99], v[76:79], v[232:235]
buffer_load_dwordx4 v[164:167], v3, s[8:11], s41 offen offset:2048
v_mfma_f32_16x16x32_bf16 v[236:239], v[96:99], v[80:83], v[236:239]
v_mfma_f32_16x16x32_bf16 v[240:243], v[100:103], v[68:71], v[240:243]
buffer_load_dwordx4 v[168:171], v3, s[8:11], s41 offen offset:3072
v_mfma_f32_16x16x32_bf16 v[244:247], v[100:103], v[72:75], v[244:247]
v_mfma_f32_16x16x32_bf16 v[248:251], v[100:103], v[76:79], v[248:251]
buffer_load_dwordx4 v[172:175], v9, s[8:11], s41 offen
v_mfma_f32_16x16x32_bf16 v[252:255], v[100:103], v[80:83], v[252:255]
s_add_u32 s41, s41, 5120
s_waitcnt vmcnt(9)
v_mfma_f32_16x16x32_bf16 v[176:179], v[120:123], v[104:107], v[176:179]
v_mfma_f32_16x16x32_bf16 v[180:183], v[120:123], v[108:111], v[180:183]
buffer_load_dwordx4 v[32:35], v3, s[8:11], s40 offen offset:0
v_mfma_f32_16x16x32_bf16 v[184:187], v[120:123], v[112:115], v[184:187]
v_mfma_f32_16x16x32_bf16 v[188:191], v[120:123], v[116:119], v[188:191]
buffer_load_dwordx4 v[36:39], v3, s[8:11], s40 offen offset:1024
v_mfma_f32_16x16x32_bf16 v[192:195], v[124:127], v[104:107], v[192:195]
v_mfma_f32_16x16x32_bf16 v[196:199], v[124:127], v[108:111], v[196:199]
buffer_load_dwordx4 v[40:43], v3, s[8:11], s40 offen offset:2048
v_mfma_f32_16x16x32_bf16 v[200:203], v[124:127], v[112:115], v[200:203]
v_mfma_f32_16x16x32_bf16 v[204:207], v[124:127], v[116:119], v[204:207]
buffer_load_dwordx4 v[44:47], v3, s[8:11], s40 offen offset:3072
v_mfma_f32_16x16x32_bf16 v[208:211], v[128:131], v[104:107], v[208:211]
v_mfma_f32_16x16x32_bf16 v[212:215], v[128:131], v[108:111], v[212:215]
s_add_u32 s40, s40, 4096
v_mfma_f32_16x16x32_bf16 v[216:219], v[128:131], v[112:115], v[216:219]
buffer_load_dwordx4 v[48:51], v3, s[8:11], s41 offen offset:0
v_mfma_f32_16x16x32_bf16 v[220:223], v[128:131], v[116:119], v[220:223]
v_mfma_f32_16x16x32_bf16 v[224:227], v[132:135], v[104:107], v[224:227]
buffer_load_dwordx4 v[52:55], v3, s[8:11], s41 offen offset:1024
v_mfma_f32_16x16x32_bf16 v[228:231], v[132:135], v[108:111], v[228:231]
v_mfma_f32_16x16x32_bf16 v[232:235], v[132:135], v[112:115], v[232:235]
buffer_load_dwordx4 v[56:59], v3, s[8:11], s41 offen offset:2048
v_mfma_f32_16x16x32_bf16 v[236:239], v[132:135], v[116:119], v[236:239]
v_mfma_f32_16x16x32_bf16 v[240:243], v[136:139], v[104:107], v[240:243]
buffer_load_dwordx4 v[60:63], v3, s[8:11], s41 offen offset:3072
v_mfma_f32_16x16x32_bf16 v[244:247], v[136:139], v[108:111], v[244:247]
v_mfma_f32_16x16x32_bf16 v[248:251], v[136:139], v[112:115], v[248:251]
buffer_load_dwordx4 v[64:67], v9, s[8:11], s41 offen
v_mfma_f32_16x16x32_bf16 v[252:255], v[136:139], v[116:119], v[252:255]
s_add_u32 s41, s41, 5120
s_waitcnt vmcnt(9)
v_mfma_f32_16x16x32_bf16 v[176:179], v[156:159], v[140:143], v[176:179]
v_mfma_f32_16x16x32_bf16 v[180:183], v[156:159], v[144:147], v[180:183]
buffer_load_dwordx4 v[68:71], v3, s[8:11], s40 offen offset:0
v_mfma_f32_16x16x32_bf16 v[184:187], v[156:159], v[148:151], v[184:187]
v_mfma_f32_16x16x32_bf16 v[188:191], v[156:159], v[152:155], v[188:191]
buffer_load_dwordx4 v[72:75], v3, s[8:11], s40 offen offset:1024
v_mfma_f32_16x16x32_bf16 v[192:195], v[160:163], v[140:143], v[192:195]
v_mfma_f32_16x16x32_bf16 v[196:199], v[160:163], v[144:147], v[196:199]
buffer_load_dwordx4 v[76:79], v3, s[8:11], s40 offen offset:2048
v_mfma_f32_16x16x32_bf16 v[200:203], v[160:163], v[148:151], v[200:203]
v_mfma_f32_16x16x32_bf16 v[204:207], v[160:163], v[152:155], v[204:207]
buffer_load_dwordx4 v[80:83], v3, s[8:11], s40 offen offset:3072
v_mfma_f32_16x16x32_bf16 v[208:211], v[164:167], v[140:143], v[208:211]
v_mfma_f32_16x16x32_bf16 v[212:215], v[164:167], v[144:147], v[212:215]
s_add_u32 s40, s40, 4096
v_mfma_f32_16x16x32_bf16 v[216:219], v[164:167], v[148:151], v[216:219]
buffer_load_dwordx4 v[84:87], v3, s[8:11], s41 offen offset:0
v_mfma_f32_16x16x32_bf16 v[220:223], v[164:167], v[152:155], v[220:223]
v_mfma_f32_16x16x32_bf16 v[224:227], v[168:171], v[140:143], v[224:227]
buffer_load_dwordx4 v[88:91], v3, s[8:11], s41 offen offset:1024
v_mfma_f32_16x16x32_bf16 v[228:231], v[168:171], v[144:147], v[228:231]
v_mfma_f32_16x16x32_bf16 v[232:235], v[168:171], v[148:151], v[232:235]
buffer_load_dwordx4 v[92:95], v3, s[8:11], s41 offen offset:2048
v_mfma_f32_16x16x32_bf16 v[236:239], v[168:171], v[152:155], v[236:239]
v_mfma_f32_16x16x32_bf16 v[240:243], v[172:175], v[140:143], v[240:243]
buffer_load_dwordx4 v[96:99], v3, s[8:11], s41 offen offset:3072
v_mfma_f32_16x16x32_bf16 v[244:247], v[172:175], v[144:147], v[244:247]
v_mfma_f32_16x16x32_bf16 v[248:251], v[172:175], v[148:151], v[248:251]
buffer_load_dwordx4 v[100:103], v9, s[8:11], s41 offen
v_mfma_f32_16x16x32_bf16 v[252:255], v[172:175], v[152:155], v[252:255]
s_add_u32 s41, s41, 5120
s_waitcnt vmcnt(9)
v_mfma_f32_16x16x32_bf16 v[176:179], v[48:51], v[32:35], v[176:179]
v_mfma_f32_16x16x32_bf16 v[180:183], v[48:51], v[36:39], v[180:183]
buffer_load_dwordx4 v[104:107], v3, s[8:11], s40 offen offset:0
v_mfma_f32_16x16x32_bf16 v[184:187], v[48:51], v[40:43], v[184:187]
v_mfma_f32_16x16x32_bf16 v[188:191], v[48:51], v[44:47], v[188:191]
buffer_load_dwordx4 v[108:111], v3, s[8:11], s40 offen offset:1024
v_mfma_f32_16x16x32_bf16 v[192:195], v[52:55], v[32:35], v[192:195]
v_mfma_f32_16x16x32_bf16 v[196:199], v[52:55], v[36:39], v[196:199]
buffer_load_dwordx4 v[112:115], v3, s[8:11], s40 offen offset:2048
v_mfma_f32_16x16x32_bf16 v[200:203], v[52:55], v[40:43], v[200:203]
v_mfma_f32_16x16x32_bf16 v[204:207], v[52:55], v[44:47], v[204:207]
buffer_load_dwordx4 v[116:119], v3, s[8:11], s40 offen offset:3072
v_mfma_f32_16x16x32_bf16 v[208:211], v[56:59], v[32:35], v[208:211]
v_mfma_f32_16x16x32_bf16 v[212:215], v[56:59], v[36:39], v[212:215]
s_add_u32 s40, s40, 4096
v_mfma_f32_16x16x32_bf16 v[216:219], v[56:59], v[40:43], v[216:219]
buffer_load_dwordx4 v[120:123], v3, s[8:11], s41 offen offset:0
v_mfma_f32_16x16x32_bf16 v[220:223], v[56:59], v[44:47], v[220:223]
v_mfma_f32_16x16x32_bf16 v[224:227], v[60:63], v[32:35], v[224:227]
buffer_load_dwordx4 v[124:127], v3, s[8:11], s41 offen offset:1024
v_mfma_f32_16x16x32_bf16 v[228:231], v[60:63], v[36:39], v[228:231]
v_mfma_f32_16x16x32_bf16 v[232:235], v[60:63], v[40:43], v[232:235]
buffer_load_dwordx4 v[128:131], v3, s[8:11], s41 offen offset:2048
v_mfma_f32_16x16x32_bf16 v[236:239], v[60:63], v[44:47], v[236:239]
v_mfma_f32_16x16x32_bf16 v[240:243], v[64:67], v[32:35], v[240:243]
buffer_load_dwordx4 v[132:135], v3, s[8:11], s41 offen offset:3072
v_mfma_f32_16x16x32_bf16 v[244:247], v[64:67], v[36:39], v[244:247]
v_mfma_f32_16x16x32_bf16 v[248:251], v[64:67], v[40:43], v[248:251]
buffer_load_dwordx4 v[136:139], v9, s[8:11], s41 offen
v_mfma_f32_16x16x32_bf16 v[252:255], v[64:67], v[44:47], v[252:255]
s_add_u32 s41, s41, 5120
s_waitcnt vmcnt(9)
v_mfma_f32_16x16x32_bf16 v[176:179], v[84:87], v[68:71], v[176:179]
v_mfma_f32_16x16x32_bf16 v[180:183], v[84:87], v[72:75], v[180:183]
buffer_load_dwordx4 v[140:143], v3, s[8:11], s40 offen offset:0
v_mfma_f32_16x16x32_bf16 v[184:187], v[84:87], v[76:79], v[184:187]
v_mfma_f32_16x16x32_bf16 v[188:191], v[84:87], v[80:83], v[188:191]
buffer_load_dwordx4 v[144:147], v3, s[8:11], s40 offen offset:1024
v_mfma_f32_16x16x32_bf16 v[192:195], v[88:91], v[68:71], v[192:195]
v_mfma_f32_16x16x32_bf16 v[196:199], v[88:91], v[72:75], v[196:199]
buffer_load_dwordx4 v[148:151], v3, s[8:11], s40 offen offset:2048
v_mfma_f32_16x16x32_bf16 v[200:203], v[88:91], v[76:79], v[200:203]
v_mfma_f32_16x16x32_bf16 v[204:207], v[88:91], v[80:83], v[204:207]
buffer_load_dwordx4 v[152:155], v3, s[8:11], s40 offen offset:3072
v_mfma_f32_16x16x32_bf16 v[208:211], v[92:95], v[68:71], v[208:211]
v_mfma_f32_16x16x32_bf16 v[212:215], v[92:95], v[72:75], v[212:215]
s_add_u32 s40, s40, 4096
v_mfma_f32_16x16x32_bf16 v[216:219], v[92:95], v[76:79], v[216:219]
buffer_load_dwordx4 v[156:159], v3, s[8:11], s41 offen offset:0
v_mfma_f32_16x16x32_bf16 v[220:223], v[92:95], v[80:83], v[220:223]
v_mfma_f32_16x16x32_bf16 v[224:227], v[96:99], v[68:71], v[224:227]
buffer_load_dwordx4 v[160:163], v3, s[8:11], s41 offen offset:1024
v_mfma_f32_16x16x32_bf16 v[228:231], v[96:99], v[72:75], v[228:231]
v_mfma_f32_16x16x32_bf16 v[232:235], v[96:99], v[76:79], v[232:235]
buffer_load_dwordx4 v[164:167], v3, s[8:11], s41 offen offset:2048
v_mfma_f32_16x16x32_bf16 v[236:239], v[96:99], v[80:83], v[236:239]
v_mfma_f32_16x16x32_bf16 v[240:243], v[100:103], v[68:71], v[240:243]
buffer_load_dwordx4 v[168:171], v3, s[8:11], s41 offen offset:3072
v_mfma_f32_16x16x32_bf16 v[244:247], v[100:103], v[72:75], v[244:247]
v_mfma_f32_16x16x32_bf16 v[248:251], v[100:103], v[76:79], v[248:251]
buffer_load_dwordx4 v[172:175], v9, s[8:11], s41 offen
v_mfma_f32_16x16x32_bf16 v[252:255], v[100:103], v[80:83], v[252:255]
s_add_u32 s41, s41, 5120
s_waitcnt vmcnt(9)
v_mfma_f32_16x16x32_bf16 v[176:179], v[120:123], v[104:107], v[176:179]
v_mfma_f32_16x16x32_bf16 v[180:183], v[120:123], v[108:111], v[180:183]
buffer_load_dwordx4 v[32:35], v3, s[8:11], s40 offen offset:0
v_mfma_f32_16x16x32_bf16 v[184:187], v[120:123], v[112:115], v[184:187]
v_mfma_f32_16x16x32_bf16 v[188:191], v[120:123], v[116:119], v[188:191]
buffer_load_dwordx4 v[36:39], v3, s[8:11], s40 offen offset:1024
v_mfma_f32_16x16x32_bf16 v[192:195], v[124:127], v[104:107], v[192:195]
v_mfma_f32_16x16x32_bf16 v[196:199], v[124:127], v[108:111], v[196:199]
buffer_load_dwordx4 v[40:43], v3, s[8:11], s40 offen offset:2048
v_mfma_f32_16x16x32_bf16 v[200:203], v[124:127], v[112:115], v[200:203]
v_mfma_f32_16x16x32_bf16 v[204:207], v[124:127], v[116:119], v[204:207]
buffer_load_dwordx4 v[44:47], v3, s[8:11], s40 offen offset:3072
v_mfma_f32_16x16x32_bf16 v[208:211], v[128:131], v[104:107], v[208:211]
v_mfma_f32_16x16x32_bf16 v[212:215], v[128:131], v[108:111], v[212:215]
s_add_u32 s40, s40, 4096
v_mfma_f32_16x16x32_bf16 v[216:219], v[128:131], v[112:115], v[216:219]
buffer_load_dwordx4 v[48:51], v3, s[8:11], s41 offen offset:0
v_mfma_f32_16x16x32_bf16 v[220:223], v[128:131], v[116:119], v[220:223]
v_mfma_f32_16x16x32_bf16 v[224:227], v[132:135], v[104:107], v[224:227]
buffer_load_dwordx4 v[52:55], v3, s[8:11], s41 offen offset:1024
v_mfma_f32_16x16x32_bf16 v[228:231], v[132:135], v[108:111], v[228:231]
v_mfma_f32_16x16x32_bf16 v[232:235], v[132:135], v[112:115], v[232:235]
buffer_load_dwordx4 v[56:59], v3, s[8:11], s41 offen offset:2048
v_mfma_f32_16x16x32_bf16 v[236:239], v[132:135], v[116:119], v[236:239]
v_mfma_f32_16x16x32_bf16 v[240:243], v[136:139], v[104:107], v[240:243]
buffer_load_dwordx4 v[60:63], v3, s[8:11], s41 offen offset:3072
v_mfma_f32_16x16x32_bf16 v[244:247], v[136:139], v[108:111], v[244:247]
v_mfma_f32_16x16x32_bf16 v[248:251], v[136:139], v[112:115], v[248:251]
buffer_load_dwordx4 v[64:67], v9, s[8:11], s41 offen
v_mfma_f32_16x16x32_bf16 v[252:255], v[136:139], v[116:119], v[252:255]
s_add_u32 s41, s41, 5120
s_waitcnt vmcnt(9)
v_mfma_f32_16x16x32_bf16 v[176:179], v[156:159], v[140:143], v[176:179]
v_mfma_f32_16x16x32_bf16 v[180:183], v[156:159], v[144:147], v[180:183]
buffer_load_dwordx4 v[68:71], v3, s[8:11], s40 offen offset:0
v_mfma_f32_16x16x32_bf16 v[184:187], v[156:159], v[148:151], v[184:187]
v_mfma_f32_16x16x32_bf16 v[188:191], v[156:159], v[152:155], v[188:191]
buffer_load_dwordx4 v[72:75], v3, s[8:11], s40 offen offset:1024
v_mfma_f32_16x16x32_bf16 v[192:195], v[160:163], v[140:143], v[192:195]
v_mfma_f32_16x16x32_bf16 v[196:199], v[160:163], v[144:147], v[196:199]
buffer_load_dwordx4 v[76:79], v3, s[8:11], s40 offen offset:2048
v_mfma_f32_16x16x32_bf16 v[200:203], v[160:163], v[148:151], v[200:203]
v_mfma_f32_16x16x32_bf16 v[204:207], v[160:163], v[152:155], v[204:207]
buffer_load_dwordx4 v[80:83], v3, s[8:11], s40 offen offset:3072
v_mfma_f32_16x16x32_bf16 v[208:211], v[164:167], v[140:143], v[208:211]
v_mfma_f32_16x16x32_bf16 v[212:215], v[164:167], v[144:147], v[212:215]
s_add_u32 s40, s40, 4096
v_mfma_f32_16x16x32_bf16 v[216:219], v[164:167], v[148:151], v[216:219]
buffer_load_dwordx4 v[84:87], v3, s[8:11], s41 offen offset:0
v_mfma_f32_16x16x32_bf16 v[220:223], v[164:167], v[152:155], v[220:223]
v_mfma_f32_16x16x32_bf16 v[224:227], v[168:171], v[140:143], v[224:227]
buffer_load_dwordx4 v[88:91], v3, s[8:11], s41 offen offset:1024
v_mfma_f32_16x16x32_bf16 v[228:231], v[168:171], v[144:147], v[228:231]
v_mfma_f32_16x16x32_bf16 v[232:235], v[168:171], v[148:151], v[232:235]
buffer_load_dwordx4 v[92:95], v3, s[8:11], s41 offen offset:2048
v_mfma_f32_16x16x32_bf16 v[236:239], v[168:171], v[152:155], v[236:239]
v_mfma_f32_16x16x32_bf16 v[240:243], v[172:175], v[140:143], v[240:243]
buffer_load_dwordx4 v[96:99], v3, s[8:11], s41 offen offset:3072
v_mfma_f32_16x16x32_bf16 v[244:247], v[172:175], v[144:147], v[244:247]
v_mfma_f32_16x16x32_bf16 v[248:251], v[172:175], v[148:151], v[248:251]
buffer_load_dwordx4 v[100:103], v9, s[8:11], s41 offen
v_mfma_f32_16x16x32_bf16 v[252:255], v[172:175], v[152:155], v[252:255]
s_add_u32 s41, s41, 5120
s_waitcnt vmcnt(9)
v_mfma_f32_16x16x32_bf16 v[176:179], v[48:51], v[32:35], v[176:179]
v_mfma_f32_16x16x32_bf16 v[180:183], v[48:51], v[36:39], v[180:183]
buffer_load_dwordx4 v[104:107], v3, s[8:11], s40 offen offset:0
v_mfma_f32_16x16x32_bf16 v[184:187], v[48:51], v[40:43], v[184:187]
v_mfma_f32_16x16x32_bf16 v[188:191], v[48:51], v[44:47], v[188:191]
buffer_load_dwordx4 v[108:111], v3, s[8:11], s40 offen offset:1024
v_mfma_f32_16x16x32_bf16 v[192:195], v[52:55], v[32:35], v[192:195]
v_mfma_f32_16x16x32_bf16 v[196:199], v[52:55], v[36:39], v[196:199]
buffer_load_dwordx4 v[112:115], v3, s[8:11], s40 offen offset:2048
v_mfma_f32_16x16x32_bf16 v[200:203], v[52:55], v[40:43], v[200:203]
v_mfma_f32_16x16x32_bf16 v[204:207], v[52:55], v[44:47], v[204:207]
buffer_load_dwordx4 v[116:119], v3, s[8:11], s40 offen offset:3072
v_mfma_f32_16x16x32_bf16 v[208:211], v[56:59], v[32:35], v[208:211]
v_mfma_f32_16x16x32_bf16 v[212:215], v[56:59], v[36:39], v[212:215]
s_add_u32 s40, s40, 4096
v_mfma_f32_16x16x32_bf16 v[216:219], v[56:59], v[40:43], v[216:219]
buffer_load_dwordx4 v[120:123], v3, s[8:11], s41 offen offset:0
v_mfma_f32_16x16x32_bf16 v[220:223], v[56:59], v[44:47], v[220:223]
v_mfma_f32_16x16x32_bf16 v[224:227], v[60:63], v[32:35], v[224:227]
buffer_load_dwordx4 v[124:127], v3, s[8:11], s41 offen offset:1024
v_mfma_f32_16x16x32_bf16 v[228:231], v[60:63], v[36:39], v[228:231]
v_mfma_f32_16x16x32_bf16 v[232:235], v[60:63], v[40:43], v[232:235]
buffer_load_dwordx4 v[128:131], v3, s[8:11], s41 offen offset:2048
v_mfma_f32_16x16x32_bf16 v[236:239], v[60:63], v[44:47], v[236:239]
v_mfma_f32_16x16x32_bf16 v[240:243], v[64:67], v[32:35], v[240:243]
buffer_load_dwordx4 v[132:135], v3, s[8:11], s41 offen offset:3072
v_mfma_f32_16x16x32_bf16 v[244:247], v[64:67], v[36:39], v[244:247]
v_mfma_f32_16x16x32_bf16 v[248:251], v[64:67], v[40:43], v[248:251]
buffer_load_dwordx4 v[136:139], v9, s[8:11], s41 offen
v_mfma_f32_16x16x32_bf16 v[252:255], v[64:67], v[44:47], v[252:255]
s_add_u32 s41, s41, 5120
s_waitcnt vmcnt(9)
v_mfma_f32_16x16x32_bf16 v[176:179], v[84:87], v[68:71], v[176:179]
v_mfma_f32_16x16x32_bf16 v[180:183], v[84:87], v[72:75], v[180:183]
v_mfma_f32_16x16x32_bf16 v[184:187], v[84:87], v[76:79], v[184:187]
v_mfma_f32_16x16x32_bf16 v[188:191], v[84:87], v[80:83], v[188:191]
v_mfma_f32_16x16x32_bf16 v[192:195], v[88:91], v[68:71], v[192:195]
v_mfma_f32_16x16x32_bf16 v[196:199], v[88:91], v[72:75], v[196:199]
v_mfma_f32_16x16x32_bf16 v[200:203], v[88:91], v[76:79], v[200:203]
v_mfma_f32_16x16x32_bf16 v[204:207], v[88:91], v[80:83], v[204:207]
v_mfma_f32_16x16x32_bf16 v[208:211], v[92:95], v[68:71], v[208:211]
v_mfma_f32_16x16x32_bf16 v[212:215], v[92:95], v[72:75], v[212:215]
v_mfma_f32_16x16x32_bf16 v[216:219], v[92:95], v[76:79], v[216:219]
v_mfma_f32_16x16x32_bf16 v[220:223], v[92:95], v[80:83], v[220:223]
v_mfma_f32_16x16x32_bf16 v[224:227], v[96:99], v[68:71], v[224:227]
v_mfma_f32_16x16x32_bf16 v[228:231], v[96:99], v[72:75], v[228:231]
v_mfma_f32_16x16x32_bf16 v[232:235], v[96:99], v[76:79], v[232:235]
v_mfma_f32_16x16x32_bf16 v[236:239], v[96:99], v[80:83], v[236:239]
v_mfma_f32_16x16x32_bf16 v[240:243], v[100:103], v[68:71], v[240:243]
v_mfma_f32_16x16x32_bf16 v[244:247], v[100:103], v[72:75], v[244:247]
v_mfma_f32_16x16x32_bf16 v[248:251], v[100:103], v[76:79], v[248:251]
v_mfma_f32_16x16x32_bf16 v[252:255], v[100:103], v[80:83], v[252:255]
s_waitcnt vmcnt(0)
v_mfma_f32_16x16x32_bf16 v[176:179], v[120:123], v[104:107], v[176:179]
v_mfma_f32_16x16x32_bf16 v[180:183], v[120:123], v[108:111], v[180:183]
v_mfma_f32_16x16x32_bf16 v[184:187], v[120:123], v[112:115], v[184:187]
v_mfma_f32_16x16x32_bf16 v[188:191], v[120:123], v[116:119], v[188:191]
v_mfma_f32_16x16x32_bf16 v[192:195], v[124:127], v[104:107], v[192:195]
v_mfma_f32_16x16x32_bf16 v[196:199], v[124:127], v[108:111], v[196:199]
v_mfma_f32_16x16x32_bf16 v[200:203], v[124:127], v[112:115], v[200:203]
v_mfma_f32_16x16x32_bf16 v[204:207], v[124:127], v[116:119], v[204:207]
v_mfma_f32_16x16x32_bf16 v[208:211], v[128:131], v[104:107], v[208:211]
v_mfma_f32_16x16x32_bf16 v[212:215], v[128:131], v[108:111], v[212:215]
v_mfma_f32_16x16x32_bf16 v[216:219], v[128:131], v[112:115], v[216:219]
v_mfma_f32_16x16x32_bf16 v[220:223], v[128:131], v[116:119], v[220:223]
v_mfma_f32_16x16x32_bf16 v[224:227], v[132:135], v[104:107], v[224:227]
v_mfma_f32_16x16x32_bf16 v[228:231], v[132:135], v[108:111], v[228:231]
v_mfma_f32_16x16x32_bf16 v[232:235], v[132:135], v[112:115], v[232:235]
v_mfma_f32_16x16x32_bf16 v[236:239], v[132:135], v[116:119], v[236:239]
v_mfma_f32_16x16x32_bf16 v[240:243], v[136:139], v[104:107], v[240:243]
v_mfma_f32_16x16x32_bf16 v[244:247], v[136:139], v[108:111], v[244:247]
v_mfma_f32_16x16x32_bf16 v[248:251], v[136:139], v[112:115], v[248:251]
v_mfma_f32_16x16x32_bf16 v[252:255], v[136:139], v[116:119], v[252:255]
s_mul_i32 s34, s20, 20480
v_add_u32 v30, s34, v3
s_nop 7
ds_write_b128 v30, v[176:179] offset:0
ds_write_b128 v30, v[180:183] offset:1024
ds_write_b128 v30, v[184:187] offset:2048
ds_write_b128 v30, v[188:191] offset:3072
ds_write_b128 v30, v[192:195] offset:4096
ds_write_b128 v30, v[196:199] offset:5120
ds_write_b128 v30, v[200:203] offset:6144
ds_write_b128 v30, v[204:207] offset:7168
ds_write_b128 v30, v[208:211] offset:8192
ds_write_b128 v30, v[212:215] offset:9216
ds_write_b128 v30, v[216:219] offset:10240
ds_write_b128 v30, v[220:223] offset:11264
ds_write_b128 v30, v[224:227] offset:12288
ds_write_b128 v30, v[228:231] offset:13312
ds_write_b128 v30, v[232:235] offset:14336
ds_write_b128 v30, v[236:239] offset:15360
ds_write_b128 v30, v[240:243] offset:16384
ds_write_b128 v30, v[244:247] offset:17408
ds_write_b128 v30, v[248:251] offset:18432
ds_write_b128 v30, v[252:255] offset:19456
s_branch L_k3_final
L_k3_owave:
s_setprio 3
s_lshl_b32 s23, s32, 2
s_and_b32 s34, s33, 3
s_add_u32 s23, s23, s34
s_lshr_b32 s24, s33, 2
v_and_b32 v4, 31, v1
v_lshrrev_b32 v5, 5, v1
s_lshl_b32 s37, s25, 7
s_add_u32 s37, s37, s23
s_mul_i32 s37, s37, 5120
s_add_u32 s37, s37, 14680064
s_waitcnt lgkmcnt(0)
s_mov_b32 s8, s4
s_and_b32 s9, s5, 0xffff
s_mov_b32 s10, 33554432
s_mov_b32 s11, 0x20000
s_lshl_b32 s36, s24, 2
s_add_u32 s36, s36, s25
s_lshl_b32 s36, s36, 5
s_add_u32 s36, s36, s23
s_mul_i32 s36, s36, 2560
s_add_u32 s36, s36, 9437184
v_lshlrev_b32 v8, 3, v1
buffer_load_dwordx4 v[16:19], v3, s[8:11], s36 offen
buffer_load_dwordx4 v[20:23], v3, s[8:11], s36 offen offset:1024
buffer_load_dwordx2 v[24:25], v8, s[8:11], s36 offen offset:2048
v_cmp_gt_u32 vcc, 21, v4
s_nop 1
s_and_saveexec_b64 s[26:27], vcc
buffer_load_dwordx4 v[64:67], v3, s[8:11], s37 offen offset:0
buffer_load_dwordx4 v[68:71], v3, s[8:11], s37 offen offset:1024
buffer_load_dwordx4 v[72:75], v3, s[8:11], s37 offen offset:2048
buffer_load_dwordx4 v[76:79], v3, s[8:11], s37 offen offset:3072
buffer_load_dwordx4 v[80:83], v9, s[8:11], s37 offen
s_add_u32 s37, s37, 163840
buffer_load_dwordx4 v[84:87], v3, s[8:11], s37 offen offset:0
buffer_load_dwordx4 v[88:91], v3, s[8:11], s37 offen offset:1024
buffer_load_dwordx4 v[92:95], v3, s[8:11], s37 offen offset:2048
buffer_load_dwordx4 v[96:99], v3, s[8:11], s37 offen offset:3072
buffer_load_dwordx4 v[100:103], v9, s[8:11], s37 offen
s_add_u32 s37, s37, 163840
buffer_load_dwordx4 v[104:107], v3, s[8:11], s37 offen offset:0
buffer_load_dwordx4 v[108:111], v3, s[8:11], s37 offen offset:1024
buffer_load_dwordx4 v[112:115], v3, s[8:11], s37 offen offset:2048
buffer_load_dwordx4 v[116:119], v3, s[8:11], s37 offen offset:3072
buffer_load_dwordx4 v[120:123], v9, s[8:11], s37 offen
s_add_u32 s37, s37, 163840
buffer_load_dwordx4 v[124:127], v3, s[8:11], s37 offen offset:0
buffer_load_dwordx4 v[128:131], v3, s[8:11], s37 offen offset:1024
buffer_load_dwordx4 v[132:135], v3, s[8:11], s37 offen offset:2048
buffer_load_dwordx4 v[136:139], v3, s[8:11], s37 offen offset:3072
buffer_load_dwordx4 v[140:143], v9, s[8:11], s37 offen
s_mov_b64 exec, s[26:27]
v_mov_b32 v10, 1
s_cmp_eq_u32 s20, 4
s_cbranch_scc0 L_k3_noinit
v_mov_b32 v12, 0
v_mov_b32 v13, 0
v_mov_b32 v14, 0
v_mov_b32 v15, 0
ds_write_b128 v2, v[12:15]
L_k3_noinit:
s_waitcnt lgkmcnt(0)
s_barrier
v_bfe_u32 v55, v4, 4, 1
v_lshlrev_b32 v55, 10, v55
v_and_b32 v56, 15, v4
v_lshl_add_u32 v55, v56, 4, v55
s_mul_i32 s44, s23, 3
v_add_u32 v52, s44, v5
v_lshrrev_b32 v56, 2, v52
v_and_b32 v52, 3, v52
v_lshlrev_b32 v52, 8, v52
v_lshl_add_u32 v52, v56, 12, v52
v_add_u32 v52, v52, v55
s_add_u32 s44, s44, 2
s_lshr_b32 s45, s44, 2
s_lshl_b32 s45, s45, 12
s_and_b32 s44, s44, 3
s_lshl_b32 s44, s44, 8
s_add_u32 s44, s44, s45
v_add_u32 v53, s44, v55
s_lshl_b32 s44, s24, 2
s_add_u32 s44, s44, s25
s_mul_i32 s44, s44, 98304
s_add_u32 s44, s44, 6291456
s_add_u32 s45, s44, 2048
s_mov_b32 s46, 0x358637bd
s_waitcnt vmcnt(20)
v_lshlrev_b32 v176, 16, v16
v_and_b32 v177, 0xffff0000, v16
v_lshlrev_b32 v178, 16, v17
v_and_b32 v179, 0xffff0000, v17
v_lshlrev_b32 v180, 16, v18
v_and_b32 v181, 0xffff0000, v18
v_lshlrev_b32 v182, 16, v19
v_and_b32 v183, 0xffff0000, v19
v_lshlrev_b32 v184, 16, v20
v_and_b32 v185, 0xffff0000, v20
v_lshlrev_b32 v186, 16, v21
v_and_b32 v187, 0xffff0000, v21
v_lshlrev_b32 v188, 16, v22
v_and_b32 v189, 0xffff0000, v22
v_lshlrev_b32 v190, 16, v23
v_and_b32 v191, 0xffff0000, v23
v_lshlrev_b32 v192, 16, v24
v_and_b32 v193, 0xffff0000, v24
v_lshlrev_b32 v194, 16, v25
v_and_b32 v195, 0xffff0000, v25
v_mov_b32 v59, 0x3fb8aa3b
v_max3_f32 v26, v176, v177, v178
v_min3_f32 v27, v176, v177, v178
v_max3_f32 v28, v179, v180, v181
v_min3_f32 v29, v179, v180, v181
v_max3_f32 v26, v26, v182, v183
v_min3_f32 v27, v27, v182, v183
v_max3_f32 v28, v28, v184, v185
v_min3_f32 v29, v29, v184, v185
v_max3_f32 v26, v26, v186, v187
v_min3_f32 v27, v27, v186, v187
v_max3_f32 v28, v28, v188, v189
v_min3_f32 v29, v29, v188, v189
v_max3_f32 v26, v26, v190, v191
v_min3_f32 v27, v27, v190, v191
v_max3_f32 v28, v28, v192, v193
v_min3_f32 v29, v29, v192, v193
v_max3_f32 v26, v26, v194, v195
v_min3_f32 v27, v27, v194, v195
v_max_f32 v26, v26, v28
v_min_f32 v27, v27, v29
v_mul_f32 v26, v59, v26
v_mul_f32 v27, v59, v27
v_fma_f32 v196, v176, v59, -v26
v_fma_f32 v216, -v176, v59, v27
v_fma_f32 v197, v177, v59, -v26
v_fma_f32 v217, -v177, v59, v27
v_fma_f32 v198, v178, v59, -v26
v_fma_f32 v218, -v178, v59, v27
v_fma_f32 v199, v179, v59, -v26
v_fma_f32 v219, -v179, v59, v27
v_fma_f32 v200, v180, v59, -v26
v_fma_f32 v220, -v180, v59, v27
v_fma_f32 v201, v181, v59, -v26
v_fma_f32 v221, -v181, v59, v27
v_fma_f32 v202, v182, v59, -v26
v_fma_f32 v222, -v182, v59, v27
v_fma_f32 v203, v183, v59, -v26
v_fma_f32 v223, -v183, v59, v27
v_fma_f32 v204, v184, v59, -v26
v_fma_f32 v224, -v184, v59, v27
v_fma_f32 v205, v185, v59, -v26
v_fma_f32 v225, -v185, v59, v27
v_fma_f32 v206, v186, v59, -v26
v_fma_f32 v226, -v186, v59, v27
v_fma_f32 v207, v187, v59, -v26
v_fma_f32 v227, -v187, v59, v27
v_fma_f32 v208, v188, v59, -v26
v_fma_f32 v228, -v188, v59, v27
v_fma_f32 v209, v189, v59, -v26
v_fma_f32 v229, -v189, v59, v27
v_fma_f32 v210, v190, v59, -v26
v_fma_f32 v230, -v190, v59, v27
v_fma_f32 v211, v191, v59, -v26
v_fma_f32 v231, -v191, v59, v27
v_fma_f32 v212, v192, v59, -v26
v_fma_f32 v232, -v192, v59, v27
v_fma_f32 v213, v193, v59, -v26
v_fma_f32 v233, -v193, v59, v27
v_fma_f32 v214, v194, v59, -v26
v_fma_f32 v234, -v194, v59, v27
v_fma_f32 v215, v195, v59, -v26
v_fma_f32 v235, -v195, v59, v27
v_exp_f32 v196, v196
v_exp_f32 v216, v216
v_exp_f32 v197, v197
v_exp_f32 v217, v217
v_exp_f32 v198, v198
v_exp_f32 v218, v218
v_exp_f32 v199, v199
v_exp_f32 v219, v219
v_exp_f32 v200, v200
v_exp_f32 v220, v220
v_exp_f32 v201, v201
v_exp_f32 v221, v221
v_exp_f32 v202, v202
v_exp_f32 v222, v222
v_exp_f32 v203, v203
v_exp_f32 v223, v223
v_exp_f32 v204, v204
v_exp_f32 v224, v224
v_exp_f32 v205, v205
v_exp_f32 v225, v225
v_exp_f32 v206, v206
v_exp_f32 v226, v226
v_exp_f32 v207, v207
v_exp_f32 v227, v227
v_exp_f32 v208, v208
v_exp_f32 v228, v228
v_exp_f32 v209, v209
v_exp_f32 v229, v229
v_exp_f32 v210, v210
v_exp_f32 v230, v230
v_exp_f32 v211, v211
v_exp_f32 v231, v231
v_exp_f32 v212, v212
v_exp_f32 v232, v232
v_exp_f32 v213, v213
v_exp_f32 v233, v233
v_exp_f32 v214, v214
v_exp_f32 v234, v234
v_exp_f32 v215, v215
v_exp_f32 v235, v235
v_pk_add_f32 v[28:29], v[196:197], v[198:199]
v_pk_add_f32 v[30:31], v[216:217], v[218:219]
v_pk_add_f32 v[28:29], v[28:29], v[200:201]
v_pk_add_f32 v[30:31], v[30:31], v[220:221]
v_pk_add_f32 v[28:29], v[28:29], v[202:203]
v_pk_add_f32 v[30:31], v[30:31], v[222:223]
v_pk_add_f32 v[28:29], v[28:29], v[204:205]
v_pk_add_f32 v[30:31], v[30:31], v[224:225]
v_pk_add_f32 v[28:29], v[28:29], v[206:207]
v_pk_add_f32 v[30:31], v[30:31], v[226:227]
v_pk_add_f32 v[28:29], v[28:29], v[208:209]
v_pk_add_f32 v[30:31], v[30:31], v[228:229]
v_pk_add_f32 v[28:29], v[28:29], v[210:211]
v_pk_add_f32 v[30:31], v[30:31], v[230:231]
v_pk_add_f32 v[28:29], v[28:29], v[212:213]
v_pk_add_f32 v[30:31], v[30:31], v[232:233]
v_pk_add_f32 v[28:29], v[28:29], v[214:215]
v_pk_add_f32 v[30:31], v[30:31], v[234:235]
v_add_f32 v28, v28, v29
v_add_f32 v30, v30, v31
v_rcp_f32 v28, v28
v_rcp_f32 v30, v30
s_nop 0
v_pk_mul_f32 v[196:197], v[196:197], v[28:29] op_sel_hi:[1,0]
v_pk_mul_f32 v[216:217], v[216:217], v[30:31] op_sel_hi:[1,0]
v_pk_mul_f32 v[198:199], v[198:199], v[28:29] op_sel_hi:[1,0]
v_pk_mul_f32 v[218:219], v[218:219], v[30:31] op_sel_hi:[1,0]
v_pk_mul_f32 v[200:201], v[200:201], v[28:29] op_sel_hi:[1,0]
v_pk_mul_f32 v[220:221], v[220:221], v[30:31] op_sel_hi:[1,0]
v_pk_mul_f32 v[202:203], v[202:203], v[28:29] op_sel_hi:[1,0]
v_pk_mul_f32 v[222:223], v[222:223], v[30:31] op_sel_hi:[1,0]
v_pk_mul_f32 v[204:205], v[204:205], v[28:29] op_sel_hi:[1,0]
v_pk_mul_f32 v[224:225], v[224:225], v[30:31] op_sel_hi:[1,0]
v_pk_mul_f32 v[206:207], v[206:207], v[28:29] op_sel_hi:[1,0]
v_pk_mul_f32 v[226:227], v[226:227], v[30:31] op_sel_hi:[1,0]
v_pk_mul_f32 v[208:209], v[208:209], v[28:29] op_sel_hi:[1,0]
v_pk_mul_f32 v[228:229], v[228:229], v[30:31] op_sel_hi:[1,0]
v_pk_mul_f32 v[210:211], v[210:211], v[28:29] op_sel_hi:[1,0]
v_pk_mul_f32 v[230:231], v[230:231], v[30:31] op_sel_hi:[1,0]
v_pk_mul_f32 v[212:213], v[212:213], v[28:29] op_sel_hi:[1,0]
v_pk_mul_f32 v[232:233], v[232:233], v[30:31] op_sel_hi:[1,0]
v_pk_mul_f32 v[214:215], v[214:215], v[28:29] op_sel_hi:[1,0]
v_pk_mul_f32 v[234:235], v[234:235], v[30:31] op_sel_hi:[1,0]
v_cvt_pk_bf16_f32 v148, v196, v197
v_cvt_pk_bf16_f32 v149, v198, v199
v_cvt_pk_bf16_f32 v150, v200, v201
v_cvt_pk_bf16_f32 v151, v202, v203
v_cvt_pk_bf16_f32 v152, v204, v205
v_cvt_pk_bf16_f32 v153, v206, v207
v_cvt_pk_bf16_f32 v154, v208, v209
v_cvt_pk_bf16_f32 v155, v210, v211
v_cvt_pk_bf16_f32 v156, v212, v213
v_cvt_pk_bf16_f32 v157, v214, v215
v_cvt_pk_bf16_f32 v158, v216, v217
v_cvt_pk_bf16_f32 v159, v218, v219
v_cvt_pk_bf16_f32 v160, v220, v221
v_cvt_pk_bf16_f32 v161, v222, v223
v_cvt_pk_bf16_f32 v162, v224, v225
v_cvt_pk_bf16_f32 v163, v226, v227
v_cvt_pk_bf16_f32 v164, v228, v229
v_cvt_pk_bf16_f32 v165, v230, v231
v_cvt_pk_bf16_f32 v168, v232, v233
v_cvt_pk_bf16_f32 v169, v234, v235
v_mov_b32 v166, 0
v_mov_b32 v167, 0
v_mov_b32 v170, 0
v_mov_b32 v171, 0
s_nop 1
v_permlane32_swap_b32 v148, v152
v_permlane32_swap_b32 v156, v160
v_permlane32_swap_b32 v149, v153
v_permlane32_swap_b32 v157, v161
v_permlane32_swap_b32 v150, v154
v_permlane32_swap_b32 v158, v162
v_permlane32_swap_b32 v151, v155
v_permlane32_swap_b32 v159, v163
v_permlane32_swap_b32 v164, v168
v_permlane32_swap_b32 v165, v169
s_waitcnt vmcnt(0)
v_add_f32 v64, v64, v84
v_add_f32 v65, v65, v85
v_add_f32 v66, v66, v86
v_add_f32 v67, v67, v87
v_add_f32 v68, v68, v88
v_add_f32 v69, v69, v89
v_add_f32 v70, v70, v90
v_add_f32 v71, v71, v91
v_add_f32 v72, v72, v92
v_add_f32 v73, v73, v93
v_add_f32 v74, v74, v94
v_add_f32 v75, v75, v95
v_add_f32 v76, v76, v96
v_add_f32 v77, v77, v97
v_add_f32 v78, v78, v98
v_add_f32 v79, v79, v99
v_add_f32 v80, v80, v100
v_add_f32 v81, v81, v101
v_add_f32 v82, v82, v102
v_add_f32 v83, v83, v103
v_add_f32 v104, v104, v124
v_add_f32 v105, v105, v125
v_add_f32 v106, v106, v126
v_add_f32 v107, v107, v127
v_add_f32 v108, v108, v128
v_add_f32 v109, v109, v129
v_add_f32 v110, v110, v130
v_add_f32 v111, v111, v131
v_add_f32 v112, v112, v132
v_add_f32 v113, v113, v133
v_add_f32 v114, v114, v134
v_add_f32 v115, v115, v135
v_add_f32 v116, v116, v136
v_add_f32 v117, v117, v137
v_add_f32 v118, v118, v138
v_add_f32 v119, v119, v139
v_add_f32 v120, v120, v140
v_add_f32 v121, v121, v141
v_add_f32 v122, v122, v142
v_add_f32 v123, v123, v143
v_add_f32 v64, v64, v104
v_add_f32 v65, v65, v105
v_add_f32 v66, v66, v106
v_add_f32 v67, v67, v107
v_add_f32 v68, v68, v108
v_add_f32 v69, v69, v109
v_add_f32 v70, v70, v110
v_add_f32 v71, v71, v111
v_add_f32 v72, v72, v112
v_add_f32 v73, v73, v113
v_add_f32 v74, v74, v114
v_add_f32 v75, v75, v115
v_add_f32 v76, v76, v116
v_add_f32 v77, v77, v117
v_add_f32 v78, v78, v118
v_add_f32 v79, v79, v119
v_add_f32 v80, v80, v120
v_add_f32 v81, v81, v121
v_add_f32 v82, v82, v122
v_add_f32 v83, v83, v123
s_mul_i32 s36, s25, 5120
s_add_u32 s36, s36, 81920
v_add_u32 v11, s36, v3
ds_write_b128 v11, v[64:67] offset:0
ds_write_b128 v11, v[68:71] offset:1024
ds_write_b128 v11, v[72:75] offset:2048
ds_write_b128 v11, v[76:79] offset:3072
ds_write_b128 v11, v[80:83] offset:4096
s_waitcnt lgkmcnt(0)
s_mov_b64 exec, 1
ds_add_u32 v2, v10 offset:0
s_mov_b64 exec, -1
s_mov_b32 s35, 0
L_spc1_10:
ds_read_b32 v12, v2 offset:0
s_waitcnt lgkmcnt(0)
v_readfirstlane_b32 s34, v12
s_add_u32 s35, s35, 1
s_cmp_ge_u32 s34, 4
s_cbranch_scc1 L_okc1_11
s_sleep 1
s_cmp_lt_u32 s35, 0x100000
s_cbranch_scc1 L_spc1_10
L_okc1_11:
s_lshl_b32 s36, s25, 10
s_add_u32 s36, s36, 81920
v_add_u32 v11, s36, v3
v_add_u32 v13, 81920, v3
ds_read_b128 v[64:67], v11 offset:0
ds_read_b128 v[68:71], v11 offset:5120
ds_read_b128 v[72:75], v11 offset:10240
ds_read_b128 v[76:79], v11 offset:15360
ds_read_b128 v[84:87], v13 offset:4096
ds_read_b128 v[88:91], v13 offset:9216
ds_read_b128 v[92:95], v13 offset:14336
ds_read_b128 v[96:99], v13 offset:19456
s_waitcnt lgkmcnt(0)
v_add_f32 v64, v64, v68
v_add_f32 v84, v84, v88
v_add_f32 v65, v65, v69
v_add_f32 v85, v85, v89
v_add_f32 v66, v66, v70
v_add_f32 v86, v86, v90
v_add_f32 v67, v67, v71
v_add_f32 v87, v87, v91
v_add_f32 v64, v64, v72
v_add_f32 v84, v84, v92
v_add_f32 v65, v65, v73
v_add_f32 v85, v85, v93
v_add_f32 v66, v66, v74
v_add_f32 v86, v86, v94
v_add_f32 v67, v67, v75
v_add_f32 v87, v87, v95
v_add_f32 v64, v64, v76
v_add_f32 v84, v84, v96
v_add_f32 v65, v65, v77
v_add_f32 v85, v85, v97
v_add_f32 v66, v66, v78
v_add_f32 v86, v86, v98
v_add_f32 v67, v67, v79
v_add_f32 v87, v87, v99
v_cvt_pk_bf16_f32 v80, v64, v65
v_cvt_pk_bf16_f32 v81, v66, v67
v_cvt_pk_bf16_f32 v48, v84, v85
v_cvt_pk_bf16_f32 v49, v86, v87
v_mov_b32 v50, 0
v_mov_b32 v51, 0
s_lshl_b32 s36, s25, 9
s_add_u32 s36, s36, 81920
v_lshlrev_b32 v11, 3, v1
v_add_u32 v12, s36, v11
v_add_u32 v11, 81920, v11
ds_write_b64 v12, v[80:81] offset:20480
s_waitcnt lgkmcnt(0)
s_mov_b64 exec, 1
ds_add_u32 v2, v10 offset:4
s_mov_b64 exec, -1
s_mov_b32 s35, 0
L_spc2_12:
ds_read_b32 v12, v2 offset:4
s_waitcnt lgkmcnt(0)
v_readfirstlane_b32 s34, v12
s_add_u32 s35, s35, 1
s_cmp_ge_u32 s34, 4
s_cbranch_scc1 L_okc2_13
s_sleep 1
s_cmp_lt_u32 s35, 0x100000
s_cbranch_scc1 L_spc2_12
L_okc2_13:
ds_read_b64 v[40:41], v11 offset:20480
ds_read_b64 v[42:43], v11 offset:20992
ds_read_b64 v[44:45], v11 offset:21504
ds_read_b64 v[46:47], v11 offset:22016
s_waitcnt vmcnt(0) lgkmcnt(0)
v_mfma_f32_32x32x16_bf16 v[64:79], v[40:43], v[148:151], 0
v_mfma_f32_32x32x16_bf16 v[64:79], v[44:47], v[156:159], v[64:79]
v_mfma_f32_32x32x16_bf16 v[64:79], v[48:51], v[164:167], v[64:79]
v_mfma_f32_32x32x16_bf16 v[80:95], v[40:43], v[152:155], 0
v_mfma_f32_32x32x16_bf16 v[80:95], v[44:47], v[160:163], v[80:95]
v_mfma_f32_32x32x16_bf16 v[80:95], v[48:51], v[168:171], v[80:95]
s_mul_i32 s37, s25, 1
s_add_u32 s37, s37, 44
s_mul_i32 s40, s21, 48
s_add_u32 s40, s40, s37
s_lshl_b32 s40, s40, 12
s_mul_i32 s41, s22, 72
s_add_u32 s41, s41, s37
s_mul_i32 s41, s41, 5120
s_add_u32 s41, s41, 17301504
s_nop 7
v_mov_b32 v57, v72
v_mov_b32 v58, v72
s_nop 1
v_permlane32_swap_b32 v57, v58
s_nop 1
v_add_f32 v58, s46, v58
v_rcp_f32 v58, v58
s_nop 0
v_mul_f32 v64, v64, v58
v_mul_f32 v65, v65, v58
v_mul_f32 v66, v66, v58
v_mul_f32 v67, v67, v58
v_mul_f32 v68, v68, v58
v_mul_f32 v69, v69, v58
v_mul_f32 v70, v70, v58
v_mul_f32 v71, v71, v58
v_mul_f32 v72, v72, v58
v_mul_f32 v73, v73, v58
v_mul_f32 v74, v74, v58
v_mul_f32 v75, v75, v58
v_cvt_pk_bf16_f32 v176, v64, v65
v_cvt_pk_bf16_f32 v177, v66, v67
v_cvt_pk_bf16_f32 v178, v68, v69
v_cvt_pk_bf16_f32 v179, v70, v71
v_cvt_pk_bf16_f32 v180, v72, v73
v_cvt_pk_bf16_f32 v181, v74, v75
v_mov_b32 v182, 0
v_mov_b32 v183, 0
buffer_store_dwordx4 v[176:179], v52, s[8:11], s44 offen sc1
s_mov_b32 exec_hi, 0
buffer_store_dwordx4 v[180:183], v53, s[8:11], s44 offen sc1
s_mov_b32 exec_hi, -1
v_mov_b32 v57, v88
v_mov_b32 v58, v88
s_nop 1
v_permlane32_swap_b32 v57, v58
s_nop 1
v_add_f32 v58, s46, v58
v_rcp_f32 v58, v58
s_nop 0
v_mul_f32 v80, v80, v58
v_mul_f32 v81, v81, v58
v_mul_f32 v82, v82, v58
v_mul_f32 v83, v83, v58
v_mul_f32 v84, v84, v58
v_mul_f32 v85, v85, v58
v_mul_f32 v86, v86, v58
v_mul_f32 v87, v87, v58
v_mul_f32 v88, v88, v58
v_mul_f32 v89, v89, v58
v_mul_f32 v90, v90, v58
v_mul_f32 v91, v91, v58
v_cvt_pk_bf16_f32 v184, v80, v81
v_cvt_pk_bf16_f32 v185, v82, v83
v_cvt_pk_bf16_f32 v186, v84, v85
v_cvt_pk_bf16_f32 v187, v86, v87
v_cvt_pk_bf16_f32 v188, v88, v89
v_cvt_pk_bf16_f32 v189, v90, v91
v_mov_b32 v190, 0
v_mov_b32 v191, 0
buffer_store_dwordx4 v[184:187], v52, s[8:11], s45 offen sc1
s_mov_b32 exec_hi, 0
buffer_store_dwordx4 v[188:191], v53, s[8:11], s45 offen sc1
s_mov_b32 exec_hi, -1
s_waitcnt vmcnt(0)
s_mov_b64 exec, 1
ds_add_u32 v2, v10 offset:8
s_mov_b64 exec, -1
s_cmp_eq_u32 s20, 4
s_cbranch_scc0 L_k3_nosig
s_mov_b32 s35, 0
L_spc3_14:
ds_read_b32 v12, v2 offset:8
s_waitcnt lgkmcnt(0)
v_readfirstlane_b32 s34, v12
s_add_u32 s35, s35, 1
s_cmp_ge_u32 s34, 4
s_cbranch_scc1 L_okc3_15
s_sleep 1
s_cmp_lt_u32 s35, 0x100000
s_cbranch_scc1 L_spc3_14
L_okc3_15:
s_lshl_b32 s34, s24, 7
s_lshl_b32 s35, s23, 2
s_add_u32 s34, s34, s35
s_add_u32 s34, s34, 20250624
v_mov_b32 v16, 0
s_mov_b64 exec, 1
buffer_store_dword v10, v16, s[8:11], s34 offen sc1
s_mov_b64 exec, -1
L_k3_nosig:
s_setprio 3
buffer_load_dwordx4 v[32:35], v3, s[8:11], s40 offen offset:0
buffer_load_dwordx4 v[36:39], v3, s[8:11], s40 offen offset:1024
buffer_load_dwordx4 v[40:43], v3, s[8:11], s40 offen offset:2048
buffer_load_dwordx4 v[44:47], v3, s[8:11], s40 offen offset:3072
s_add_u32 s40, s40, 4096
buffer_load_dwordx4 v[48:51], v3, s[8:11], s41 offen offset:0
buffer_load_dwordx4 v[52:55], v3, s[8:11], s41 offen offset:1024
buffer_load_dwordx4 v[56:59], v3, s[8:11], s41 offen offset:2048
buffer_load_dwordx4 v[60:63], v3, s[8:11], s41 offen offset:3072
buffer_load_dwordx4 v[64:67], v9, s[8:11], s41 offen
s_add_u32 s41, s41, 5120
s_mov_b32 s12, s6
s_and_b32 s13, s7, 0xffff
s_mov_b32 s14, 2621440
s_mov_b32 s15, 0x20000
v_mul_u32_u24 v18, 6554, v0
v_lshrrev_b32 v18, 16, v18
v_mul_u32_u24 v19, 10, v18
v_sub_u32 v19, v0, v19
v_mul_u32_u24 v28, 1280, v18
v_lshl_add_u32 v28, v19, 4, v28
v_add_u32 v16, 512, v0
v_mul_u32_u24 v17, 6554, v16
v_lshrrev_b32 v17, 16, v17
v_mul_u32_u24 v29, 10, v17
v_sub_u32 v16, v16, v29
v_mul_u32_u24 v29, 1280, v17
v_lshl_add_u32 v29, v16, 4, v29
s_mul_i32 s26, s21, 81920
s_mul_i32 s34, s22, 160
s_add_u32 s26, s26, s34
buffer_load_dwordx4 v[20:23], v28, s[12:15], s26 offen
s_cmp_lt_u32 s20, 2
s_cbranch_scc0 L_x2_16
buffer_load_dwordx4 v[24:27], v29, s[12:15], s26 offen
L_x2_16:
s_waitcnt vmcnt(1)
v_mfma_f32_16x16x32_bf16 v[176:179], v[48:51], v[32:35], 0
v_mfma_f32_16x16x32_bf16 v[180:183], v[48:51], v[36:39], 0
v_mfma_f32_16x16x32_bf16 v[184:187], v[48:51], v[40:43], 0
v_mfma_f32_16x16x32_bf16 v[188:191], v[48:51], v[44:47], 0
v_mfma_f32_16x16x32_bf16 v[192:195], v[52:55], v[32:35], 0
v_mfma_f32_16x16x32_bf16 v[196:199], v[52:55], v[36:39], 0
v_mfma_f32_16x16x32_bf16 v[200:203], v[52:55], v[40:43], 0
v_mfma_f32_16x16x32_bf16 v[204:207], v[52:55], v[44:47], 0
v_mfma_f32_16x16x32_bf16 v[208:211], v[56:59], v[32:35], 0
v_mfma_f32_16x16x32_bf16 v[212:215], v[56:59], v[36:39], 0
v_mfma_f32_16x16x32_bf16 v[216:219], v[56:59], v[40:43], 0
v_mfma_f32_16x16x32_bf16 v[220:223], v[56:59], v[44:47], 0
v_mfma_f32_16x16x32_bf16 v[224:227], v[60:63], v[32:35], 0
v_mfma_f32_16x16x32_bf16 v[228:231], v[60:63], v[36:39], 0
v_mfma_f32_16x16x32_bf16 v[232:235], v[60:63], v[40:43], 0
v_mfma_f32_16x16x32_bf16 v[236:239], v[60:63], v[44:47], 0
v_mfma_f32_16x16x32_bf16 v[240:243], v[64:67], v[32:35], 0
v_mfma_f32_16x16x32_bf16 v[244:247], v[64:67], v[36:39], 0
v_mfma_f32_16x16x32_bf16 v[248:251], v[64:67], v[40:43], 0
v_mfma_f32_16x16x32_bf16 v[252:255], v[64:67], v[44:47], 0
s_mul_i32 s37, s25, 6
s_mul_i32 s40, s21, 24
s_add_u32 s40, s40, s37
s_lshl_b32 s40, s40, 12
s_add_u32 s40, s40, 6291456
s_mul_i32 s41, s22, 72
s_add_u32 s41, s41, s37
s_add_u32 s41, s41, 48
s_mul_i32 s41, s41, 5120
s_add_u32 s41, s41, 17301504
s_cmp_eq_u32 s20, 4
s_cbranch_scc0 L_k3_nopoll
s_lshr_b32 s36, s21, 2
s_lshl_b32 s36, s36, 7
s_add_u32 s36, s36, 20250624
v_lshlrev_b32 v16, 2, v4
s_mov_b32 s35, 0
L_k3_poll:
buffer_load_dword v17, v16, s[8:11], s36 offen sc1
s_waitcnt vmcnt(0)
v_cmp_ne_u32 vcc, 1, v17
s_add_u32 s35, s35, 1
s_cmp_eq_u64 vcc, 0
s_cbranch_scc1 L_k3_rdy
s_sleep 2
s_cmp_lt_u32 s35, 0x40000
s_cbranch_scc1 L_k3_poll
L_k3_rdy:
s_mov_b64 exec, 1
ds_write_b32 v2, v10 offset:12
s_mov_b64 exec, -1
L_k3_nopoll:
buffer_load_dwordx4 v[84:87], v3, s[8:11], s41 offen offset:0
buffer_load_dwordx4 v[88:91], v3, s[8:11], s41 offen offset:1024
buffer_load_dwordx4 v[92:95], v3, s[8:11], s41 offen offset:2048
buffer_load_dwordx4 v[96:99], v3, s[8:11], s41 offen offset:3072
buffer_load_dwordx4 v[100:103], v9, s[8:11], s41 offen
s_add_u32 s41, s41, 5120
buffer_load_dwordx4 v[120:123], v3, s[8:11], s41 offen offset:0
buffer_load_dwordx4 v[124:127], v3, s[8:11], s41 offen offset:1024
buffer_load_dwordx4 v[128:131], v3, s[8:11], s41 offen offset:2048
buffer_load_dwordx4 v[132:135], v3, s[8:11], s41 offen offset:3072
buffer_load_dwordx4 v[136:139], v9, s[8:11], s41 offen
s_add_u32 s41, s41, 5120
buffer_load_dwordx4 v[156:159], v3, s[8:11], s41 offen offset:0
buffer_load_dwordx4 v[160:163], v3, s[8:11], s41 offen offset:1024
buffer_load_dwordx4 v[164:167], v3, s[8:11], s41 offen offset:2048
buffer_load_dwordx4 v[168:171], v3, s[8:11], s41 offen offset:3072
buffer_load_dwordx4 v[172:175], v9, s[8:11], s41 offen
s_add_u32 s41, s41, 5120
s_mov_b32 s35, 0
L_sprdy_17:
ds_read_b32 v12, v2 offset:12
s_waitcnt lgkmcnt(0)
v_readfirstlane_b32 s34, v12
s_add_u32 s35, s35, 1
s_cmp_ge_u32 s34, 1
s_cbranch_scc1 L_okrdy_18
s_sleep 1
s_cmp_lt_u32 s35, 0x100000
s_cbranch_scc1 L_sprdy_17
L_okrdy_18:
buffer_load_dwordx4 v[68:71], v3, s[8:11], s40 offen offset:0 sc1
buffer_load_dwordx4 v[72:75], v3, s[8:11], s40 offen offset:1024 sc1
buffer_load_dwordx4 v[76:79], v3, s[8:11], s40 offen offset:2048 sc1
buffer_load_dwordx4 v[80:83], v3, s[8:11], s40 offen offset:3072 sc1
s_add_u32 s40, s40, 4096
buffer_load_dwordx4 v[104:107], v3, s[8:11], s40 offen offset:0 sc1
buffer_load_dwordx4 v[108:111], v3, s[8:11], s40 offen offset:1024 sc1
buffer_load_dwordx4 v[112:115], v3, s[8:11], s40 offen offset:2048 sc1
buffer_load_dwordx4 v[116:119], v3, s[8:11], s40 offen offset:3072 sc1
s_add_u32 s40, s40, 4096
buffer_load_dwordx4 v[140:143], v3, s[8:11], s40 offen offset:0 sc1
buffer_load_dwordx4 v[144:147], v3, s[8:11], s40 offen offset:1024 sc1
buffer_load_dwordx4 v[148:151], v3, s[8:11], s40 offen offset:2048 sc1
buffer_load_dwordx4 v[152:155], v3, s[8:11], s40 offen offset:3072 sc1
s_add_u32 s40, s40, 4096
s_waitcnt vmcnt(8)
v_mfma_f32_16x16x32_bf16 v[176:179], v[84:87], v[68:71], v[176:179]
v_mfma_f32_16x16x32_bf16 v[180:183], v[84:87], v[72:75], v[180:183]
buffer_load_dwordx4 v[32:35], v3, s[8:11], s40 offen offset:0 sc1
v_mfma_f32_16x16x32_bf16 v[184:187], v[84:87], v[76:79], v[184:187]
v_mfma_f32_16x16x32_bf16 v[188:191], v[84:87], v[80:83], v[188:191]
buffer_load_dwordx4 v[36:39], v3, s[8:11], s40 offen offset:1024 sc1
v_mfma_f32_16x16x32_bf16 v[192:195], v[88:91], v[68:71], v[192:195]
v_mfma_f32_16x16x32_bf16 v[196:199], v[88:91], v[72:75], v[196:199]
buffer_load_dwordx4 v[40:43], v3, s[8:11], s40 offen offset:2048 sc1
v_mfma_f32_16x16x32_bf16 v[200:203], v[88:91], v[76:79], v[200:203]
v_mfma_f32_16x16x32_bf16 v[204:207], v[88:91], v[80:83], v[204:207]
buffer_load_dwordx4 v[44:47], v3, s[8:11], s40 offen offset:3072 sc1
v_mfma_f32_16x16x32_bf16 v[208:211], v[92:95], v[68:71], v[208:211]
v_mfma_f32_16x16x32_bf16 v[212:215], v[92:95], v[72:75], v[212:215]
s_add_u32 s40, s40, 4096
v_mfma_f32_16x16x32_bf16 v[216:219], v[92:95], v[76:79], v[216:219]
buffer_load_dwordx4 v[48:51], v3, s[8:11], s41 offen offset:0
v_mfma_f32_16x16x32_bf16 v[220:223], v[92:95], v[80:83], v[220:223]
v_mfma_f32_16x16x32_bf16 v[224:227], v[96:99], v[68:71], v[224:227]
buffer_load_dwordx4 v[52:55], v3, s[8:11], s41 offen offset:1024
v_mfma_f32_16x16x32_bf16 v[228:231], v[96:99], v[72:75], v[228:231]
v_mfma_f32_16x16x32_bf16 v[232:235], v[96:99], v[76:79], v[232:235]
buffer_load_dwordx4 v[56:59], v3, s[8:11], s41 offen offset:2048
v_mfma_f32_16x16x32_bf16 v[236:239], v[96:99], v[80:83], v[236:239]
v_mfma_f32_16x16x32_bf16 v[240:243], v[100:103], v[68:71], v[240:243]
buffer_load_dwordx4 v[60:63], v3, s[8:11], s41 offen offset:3072
v_mfma_f32_16x16x32_bf16 v[244:247], v[100:103], v[72:75], v[244:247]
v_mfma_f32_16x16x32_bf16 v[248:251], v[100:103], v[76:79], v[248:251]
buffer_load_dwordx4 v[64:67], v9, s[8:11], s41 offen
v_mfma_f32_16x16x32_bf16 v[252:255], v[100:103], v[80:83], v[252:255]
s_add_u32 s41, s41, 5120
s_waitcnt vmcnt(13)
v_mfma_f32_16x16x32_bf16 v[176:179], v[120:123], v[104:107], v[176:179]
v_mfma_f32_16x16x32_bf16 v[180:183], v[120:123], v[108:111], v[180:183]
buffer_load_dwordx4 v[68:71], v3, s[8:11], s40 offen offset:0 sc1
v_mfma_f32_16x16x32_bf16 v[184:187], v[120:123], v[112:115], v[184:187]
v_mfma_f32_16x16x32_bf16 v[188:191], v[120:123], v[116:119], v[188:191]
buffer_load_dwordx4 v[72:75], v3, s[8:11], s40 offen offset:1024 sc1
v_mfma_f32_16x16x32_bf16 v[192:195], v[124:127], v[104:107], v[192:195]
v_mfma_f32_16x16x32_bf16 v[196:199], v[124:127], v[108:111], v[196:199]
buffer_load_dwordx4 v[76:79], v3, s[8:11], s40 offen offset:2048 sc1
v_mfma_f32_16x16x32_bf16 v[200:203], v[124:127], v[112:115], v[200:203]
v_mfma_f32_16x16x32_bf16 v[204:207], v[124:127], v[116:119], v[204:207]
buffer_load_dwordx4 v[80:83], v3, s[8:11], s40 offen offset:3072 sc1
v_mfma_f32_16x16x32_bf16 v[208:211], v[128:131], v[104:107], v[208:211]
v_mfma_f32_16x16x32_bf16 v[212:215], v[128:131], v[108:111], v[212:215]
s_add_u32 s40, s40, 4096
v_mfma_f32_16x16x32_bf16 v[216:219], v[128:131], v[112:115], v[216:219]
buffer_load_dwordx4 v[84:87], v3, s[8:11], s41 offen offset:0
v_mfma_f32_16x16x32_bf16 v[220:223], v[128:131], v[116:119], v[220:223]
v_mfma_f32_16x16x32_bf16 v[224:227], v[132:135], v[104:107], v[224:227]
buffer_load_dwordx4 v[88:91], v3, s[8:11], s41 offen offset:1024
v_mfma_f32_16x16x32_bf16 v[228:231], v[132:135], v[108:111], v[228:231]
v_mfma_f32_16x16x32_bf16 v[232:235], v[132:135], v[112:115], v[232:235]
buffer_load_dwordx4 v[92:95], v3, s[8:11], s41 offen offset:2048
v_mfma_f32_16x16x32_bf16 v[236:239], v[132:135], v[116:119], v[236:239]
v_mfma_f32_16x16x32_bf16 v[240:243], v[136:139], v[104:107], v[240:243]
buffer_load_dwordx4 v[96:99], v3, s[8:11], s41 offen offset:3072
v_mfma_f32_16x16x32_bf16 v[244:247], v[136:139], v[108:111], v[244:247]
v_mfma_f32_16x16x32_bf16 v[248:251], v[136:139], v[112:115], v[248:251]
buffer_load_dwordx4 v[100:103], v9, s[8:11], s41 offen
v_mfma_f32_16x16x32_bf16 v[252:255], v[136:139], v[116:119], v[252:255]
s_add_u32 s41, s41, 5120
s_waitcnt vmcnt(18)
v_mfma_f32_16x16x32_bf16 v[176:179], v[156:159], v[140:143], v[176:179]
v_mfma_f32_16x16x32_bf16 v[180:183], v[156:159], v[144:147], v[180:183]
buffer_load_dwordx4 v[104:107], v3, s[8:11], s40 offen offset:0 sc1
v_mfma_f32_16x16x32_bf16 v[184:187], v[156:159], v[148:151], v[184:187]
v_mfma_f32_16x16x32_bf16 v[188:191], v[156:159], v[152:155], v[188:191]
buffer_load_dwordx4 v[108:111], v3, s[8:11], s40 offen offset:1024 sc1
v_mfma_f32_16x16x32_bf16 v[192:195], v[160:163], v[140:143], v[192:195]
v_mfma_f32_16x16x32_bf16 v[196:199], v[160:163], v[144:147], v[196:199]
buffer_load_dwordx4 v[112:115], v3, s[8:11], s40 offen offset:2048 sc1
v_mfma_f32_16x16x32_bf16 v[200:203], v[160:163], v[148:151], v[200:203]
v_mfma_f32_16x16x32_bf16 v[204:207], v[160:163], v[152:155], v[204:207]
buffer_load_dwordx4 v[116:119], v3, s[8:11], s40 offen offset:3072 sc1
v_mfma_f32_16x16x32_bf16 v[208:211], v[164:167], v[140:143], v[208:211]
v_mfma_f32_16x16x32_bf16 v[212:215], v[164:167], v[144:147], v[212:215]
s_add_u32 s40, s40, 4096
v_mfma_f32_16x16x32_bf16 v[216:219], v[164:167], v[148:151], v[216:219]
buffer_load_dwordx4 v[120:123], v3, s[8:11], s41 offen offset:0
v_mfma_f32_16x16x32_bf16 v[220:223], v[164:167], v[152:155], v[220:223]
v_mfma_f32_16x16x32_bf16 v[224:227], v[168:171], v[140:143], v[224:227]
buffer_load_dwordx4 v[124:127], v3, s[8:11], s41 offen offset:1024
v_mfma_f32_16x16x32_bf16 v[228:231], v[168:171], v[144:147], v[228:231]
v_mfma_f32_16x16x32_bf16 v[232:235], v[168:171], v[148:151], v[232:235]
buffer_load_dwordx4 v[128:131], v3, s[8:11], s41 offen offset:2048
v_mfma_f32_16x16x32_bf16 v[236:239], v[168:171], v[152:155], v[236:239]
v_mfma_f32_16x16x32_bf16 v[240:243], v[172:175], v[140:143], v[240:243]
buffer_load_dwordx4 v[132:135], v3, s[8:11], s41 offen offset:3072
v_mfma_f32_16x16x32_bf16 v[244:247], v[172:175], v[144:147], v[244:247]
v_mfma_f32_16x16x32_bf16 v[248:251], v[172:175], v[148:151], v[248:251]
buffer_load_dwordx4 v[136:139], v9, s[8:11], s41 offen
v_mfma_f32_16x16x32_bf16 v[252:255], v[172:175], v[152:155], v[252:255]
s_add_u32 s41, s41, 5120
s_waitcnt vmcnt(18)
v_mfma_f32_16x16x32_bf16 v[176:179], v[48:51], v[32:35], v[176:179]
v_mfma_f32_16x16x32_bf16 v[180:183], v[48:51], v[36:39], v[180:183]
v_mfma_f32_16x16x32_bf16 v[184:187], v[48:51], v[40:43], v[184:187]
v_mfma_f32_16x16x32_bf16 v[188:191], v[48:51], v[44:47], v[188:191]
v_mfma_f32_16x16x32_bf16 v[192:195], v[52:55], v[32:35], v[192:195]
v_mfma_f32_16x16x32_bf16 v[196:199], v[52:55], v[36:39], v[196:199]
v_mfma_f32_16x16x32_bf16 v[200:203], v[52:55], v[40:43], v[200:203]
v_mfma_f32_16x16x32_bf16 v[204:207], v[52:55], v[44:47], v[204:207]
v_mfma_f32_16x16x32_bf16 v[208:211], v[56:59], v[32:35], v[208:211]
v_mfma_f32_16x16x32_bf16 v[212:215], v[56:59], v[36:39], v[212:215]
v_mfma_f32_16x16x32_bf16 v[216:219], v[56:59], v[40:43], v[216:219]
v_mfma_f32_16x16x32_bf16 v[220:223], v[56:59], v[44:47], v[220:223]
v_mfma_f32_16x16x32_bf16 v[224:227], v[60:63], v[32:35], v[224:227]
v_mfma_f32_16x16x32_bf16 v[228:231], v[60:63], v[36:39], v[228:231]
v_mfma_f32_16x16x32_bf16 v[232:235], v[60:63], v[40:43], v[232:235]
v_mfma_f32_16x16x32_bf16 v[236:239], v[60:63], v[44:47], v[236:239]
v_mfma_f32_16x16x32_bf16 v[240:243], v[64:67], v[32:35], v[240:243]
v_mfma_f32_16x16x32_bf16 v[244:247], v[64:67], v[36:39], v[244:247]
v_mfma_f32_16x16x32_bf16 v[248:251], v[64:67], v[40:43], v[248:251]
v_mfma_f32_16x16x32_bf16 v[252:255], v[64:67], v[44:47], v[252:255]
s_waitcnt vmcnt(9)
v_mfma_f32_16x16x32_bf16 v[176:179], v[84:87], v[68:71], v[176:179]
v_mfma_f32_16x16x32_bf16 v[180:183], v[84:87], v[72:75], v[180:183]
v_mfma_f32_16x16x32_bf16 v[184:187], v[84:87], v[76:79], v[184:187]
v_mfma_f32_16x16x32_bf16 v[188:191], v[84:87], v[80:83], v[188:191]
v_mfma_f32_16x16x32_bf16 v[192:195], v[88:91], v[68:71], v[192:195]
v_mfma_f32_16x16x32_bf16 v[196:199], v[88:91], v[72:75], v[196:199]
v_mfma_f32_16x16x32_bf16 v[200:203], v[88:91], v[76:79], v[200:203]
v_mfma_f32_16x16x32_bf16 v[204:207], v[88:91], v[80:83], v[204:207]
v_mfma_f32_16x16x32_bf16 v[208:211], v[92:95], v[68:71], v[208:211]
v_mfma_f32_16x16x32_bf16 v[212:215], v[92:95], v[72:75], v[212:215]
v_mfma_f32_16x16x32_bf16 v[216:219], v[92:95], v[76:79], v[216:219]
v_mfma_f32_16x16x32_bf16 v[220:223], v[92:95], v[80:83], v[220:223]
v_mfma_f32_16x16x32_bf16 v[224:227], v[96:99], v[68:71], v[224:227]
v_mfma_f32_16x16x32_bf16 v[228:231], v[96:99], v[72:75], v[228:231]
v_mfma_f32_16x16x32_bf16 v[232:235], v[96:99], v[76:79], v[232:235]
v_mfma_f32_16x16x32_bf16 v[236:239], v[96:99], v[80:83], v[236:239]
v_mfma_f32_16x16x32_bf16 v[240:243], v[100:103], v[68:71], v[240:243]
v_mfma_f32_16x16x32_bf16 v[244:247], v[100:103], v[72:75], v[244:247]
v_mfma_f32_16x16x32_bf16 v[248:251], v[100:103], v[76:79], v[248:251]
v_mfma_f32_16x16x32_bf16 v[252:255], v[100:103], v[80:83], v[252:255]
s_waitcnt vmcnt(0)
v_mfma_f32_16x16x32_bf16 v[176:179], v[120:123], v[104:107], v[176:179]
v_mfma_f32_16x16x32_bf16 v[180:183], v[120:123], v[108:111], v[180:183]
v_mfma_f32_16x16x32_bf16 v[184:187], v[120:123], v[112:115], v[184:187]
v_mfma_f32_16x16x32_bf16 v[188:191], v[120:123], v[116:119], v[188:191]
v_mfma_f32_16x16x32_bf16 v[192:195], v[124:127], v[104:107], v[192:195]
v_mfma_f32_16x16x32_bf16 v[196:199], v[124:127], v[108:111], v[196:199]
v_mfma_f32_16x16x32_bf16 v[200:203], v[124:127], v[112:115], v[200:203]
v_mfma_f32_16x16x32_bf16 v[204:207], v[124:127], v[116:119], v[204:207]
v_mfma_f32_16x16x32_bf16 v[208:211], v[128:131], v[104:107], v[208:211]
v_mfma_f32_16x16x32_bf16 v[212:215], v[128:131], v[108:111], v[212:215]
v_mfma_f32_16x16x32_bf16 v[216:219], v[128:131], v[112:115], v[216:219]
v_mfma_f32_16x16x32_bf16 v[220:223], v[128:131], v[116:119], v[220:223]
v_mfma_f32_16x16x32_bf16 v[224:227], v[132:135], v[104:107], v[224:227]
v_mfma_f32_16x16x32_bf16 v[228:231], v[132:135], v[108:111], v[228:231]
v_mfma_f32_16x16x32_bf16 v[232:235], v[132:135], v[112:115], v[232:235]
v_mfma_f32_16x16x32_bf16 v[236:239], v[132:135], v[116:119], v[236:239]
v_mfma_f32_16x16x32_bf16 v[240:243], v[136:139], v[104:107], v[240:243]
v_mfma_f32_16x16x32_bf16 v[244:247], v[136:139], v[108:111], v[244:247]
v_mfma_f32_16x16x32_bf16 v[248:251], v[136:139], v[112:115], v[248:251]
v_mfma_f32_16x16x32_bf16 v[252:255], v[136:139], v[116:119], v[252:255]
s_mul_i32 s34, s20, 20480
v_add_u32 v30, s34, v3
s_nop 7
ds_write_b128 v30, v[176:179] offset:0
ds_write_b128 v30, v[180:183] offset:1024
ds_write_b128 v30, v[184:187] offset:2048
ds_write_b128 v30, v[188:191] offset:3072
ds_write_b128 v30, v[192:195] offset:4096
ds_write_b128 v30, v[196:199] offset:5120
ds_write_b128 v30, v[200:203] offset:6144
ds_write_b128 v30, v[204:207] offset:7168
ds_write_b128 v30, v[208:211] offset:8192
ds_write_b128 v30, v[212:215] offset:9216
ds_write_b128 v30, v[216:219] offset:10240
ds_write_b128 v30, v[220:223] offset:11264
ds_write_b128 v30, v[224:227] offset:12288
ds_write_b128 v30, v[228:231] offset:13312
ds_write_b128 v30, v[232:235] offset:14336
ds_write_b128 v30, v[236:239] offset:15360
ds_write_b128 v30, v[240:243] offset:16384
ds_write_b128 v30, v[244:247] offset:17408
ds_write_b128 v30, v[248:251] offset:18432
ds_write_b128 v30, v[252:255] offset:19456
L_k3_final:
s_mov_b32 s16, s28
s_and_b32 s17, s29, 0xffff
s_mov_b32 s18, 2621440
s_mov_b32 s19, 0x20000
s_lshl_b32 s34, s20, 10
v_add_u32 v30, s34, v3
v_add_u32 v31, 61440, v30
v_add_u32 v15, 122880, v30
v_and_b32 v12, 15, v1
v_lshrrev_b32 v13, 4, v1
v_and_b32 v14, 3, v12
v_xor_b32 v13, v13, v14
v_lshlrev_b32 v12, 6, v12
v_lshl_add_u32 v12, v13, 4, v12
v_add_u32 v12, s34, v12
v_lshrrev_b32 v10, 1, v19
v_lshlrev_b32 v10, 2, v10
v_lshrrev_b32 v11, 4, v18
v_add_u32 v10, v10, v11
v_and_b32 v11, 15, v18
v_lshlrev_b32 v10, 10, v10
v_lshl_add_u32 v10, v11, 6, v10
v_and_b32 v13, 1, v19
v_lshlrev_b32 v13, 1, v13
v_and_b32 v14, 3, v11
v_xor_b32 v11, v13, v14
v_lshl_add_u32 v4, v11, 4, v10
v_xor_b32 v5, 16, v4
v_lshrrev_b32 v10, 1, v16
v_lshlrev_b32 v10, 2, v10
v_lshrrev_b32 v11, 4, v17
v_add_u32 v10, v10, v11
v_and_b32 v11, 15, v17
v_lshlrev_b32 v10, 10, v10
v_lshl_add_u32 v10, v11, 6, v10
v_and_b32 v13, 1, v16
v_lshlrev_b32 v13, 1, v13
v_and_b32 v14, 3, v11
v_xor_b32 v11, v13, v14
v_lshl_add_u32 v6, v11, 4, v10
v_xor_b32 v7, 16, v6
s_waitcnt lgkmcnt(0)
s_barrier
ds_read_b128 v[32:35], v30 offset:0
ds_read_b128 v[36:39], v30 offset:20480
ds_read_b128 v[40:43], v30 offset:40960
ds_read_b128 v[44:47], v31 offset:0
ds_read_b128 v[48:51], v31 offset:20480
ds_read_b128 v[52:55], v31 offset:40960
ds_read_b128 v[56:59], v15 offset:0
ds_read_b128 v[60:63], v15 offset:20480
ds_read_b128 v[64:67], v30 offset:8192
ds_read_b128 v[68:71], v30 offset:28672
ds_read_b128 v[72:75], v30 offset:49152
ds_read_b128 v[76:79], v31 offset:8192
ds_read_b128 v[80:83], v31 offset:28672
ds_read_b128 v[84:87], v31 offset:49152
ds_read_b128 v[88:91], v15 offset:8192
ds_read_b128 v[92:95], v15 offset:28672
s_cmp_ge_u32 s20, 4
s_cbranch_scc1 L_k3_two_19
ds_read_b128 v[96:99], v30 offset:16384
ds_read_b128 v[100:103], v30 offset:36864
ds_read_b128 v[104:107], v30 offset:57344
ds_read_b128 v[108:111], v31 offset:16384
ds_read_b128 v[112:115], v31 offset:36864
ds_read_b128 v[116:119], v31 offset:57344
ds_read_b128 v[120:123], v15 offset:16384
ds_read_b128 v[124:127], v15 offset:36864
s_waitcnt lgkmcnt(15)
v_add_f32 v32, v32, v36
v_add_f32 v33, v33, v37
v_add_f32 v34, v34, v38
v_add_f32 v35, v35, v39
v_add_f32 v40, v40, v44
v_add_f32 v41, v41, v45
v_add_f32 v42, v42, v46
v_add_f32 v43, v43, v47
v_add_f32 v48, v48, v52
v_add_f32 v49, v49, v53
v_add_f32 v50, v50, v54
v_add_f32 v51, v51, v55
v_add_f32 v56, v56, v60
v_add_f32 v57, v57, v61
v_add_f32 v58, v58, v62
v_add_f32 v59, v59, v63
v_add_f32 v32, v32, v40
v_add_f32 v33, v33, v41
v_add_f32 v34, v34, v42
v_add_f32 v35, v35, v43
v_add_f32 v48, v48, v56
v_add_f32 v49, v49, v57
v_add_f32 v50, v50, v58
v_add_f32 v51, v51, v59
v_add_f32 v32, v32, v48
v_add_f32 v33, v33, v49
v_add_f32 v34, v34, v50
v_add_f32 v35, v35, v51
s_waitcnt lgkmcnt(8)
v_add_f32 v64, v64, v68
v_add_f32 v65, v65, v69
v_add_f32 v66, v66, v70
v_add_f32 v67, v67, v71
v_add_f32 v72, v72, v76
v_add_f32 v73, v73, v77
v_add_f32 v74, v74, v78
v_add_f32 v75, v75, v79
v_add_f32 v80, v80, v84
v_add_f32 v81, v81, v85
v_add_f32 v82, v82, v86
v_add_f32 v83, v83, v87
v_add_f32 v88, v88, v92
v_add_f32 v89, v89, v93
v_add_f32 v90, v90, v94
v_add_f32 v91, v91, v95
v_add_f32 v64, v64, v72
v_add_f32 v65, v65, v73
v_add_f32 v66, v66, v74
v_add_f32 v67, v67, v75
v_add_f32 v80, v80, v88
v_add_f32 v81, v81, v89
v_add_f32 v82, v82, v90
v_add_f32 v83, v83, v91
v_add_f32 v64, v64, v80
v_add_f32 v65, v65, v81
v_add_f32 v66, v66, v82
v_add_f32 v67, v67, v83
s_waitcnt lgkmcnt(0)
v_add_f32 v96, v96, v100
v_add_f32 v97, v97, v101
v_add_f32 v98, v98, v102
v_add_f32 v99, v99, v103
v_add_f32 v104, v104, v108
v_add_f32 v105, v105, v109
v_add_f32 v106, v106, v110
v_add_f32 v107, v107, v111
v_add_f32 v112, v112, v116
v_add_f32 v113, v113, v117
v_add_f32 v114, v114, v118
v_add_f32 v115, v115, v119
v_add_f32 v120, v120, v124
v_add_f32 v121, v121, v125
v_add_f32 v122, v122, v126
v_add_f32 v123, v123, v127
v_add_f32 v96, v96, v104
v_add_f32 v97, v97, v105
v_add_f32 v98, v98, v106
v_add_f32 v99, v99, v107
v_add_f32 v112, v112, v120
v_add_f32 v113, v113, v121
v_add_f32 v114, v114, v122
v_add_f32 v115, v115, v123
v_add_f32 v96, v96, v112
v_add_f32 v97, v97, v113
v_add_f32 v98, v98, v114
v_add_f32 v99, v99, v115
ds_write_b128 v12, v[96:99] offset:16384
s_branch L_k3_s_20
L_k3_two_19:
s_waitcnt lgkmcnt(8)
v_add_f32 v32, v32, v36
v_add_f32 v33, v33, v37
v_add_f32 v34, v34, v38
v_add_f32 v35, v35, v39
v_add_f32 v40, v40, v44
v_add_f32 v41, v41, v45
v_add_f32 v42, v42, v46
v_add_f32 v43, v43, v47
v_add_f32 v48, v48, v52
v_add_f32 v49, v49, v53
v_add_f32 v50, v50, v54
v_add_f32 v51, v51, v55
v_add_f32 v56, v56, v60
v_add_f32 v57, v57, v61
v_add_f32 v58, v58, v62
v_add_f32 v59, v59, v63
v_add_f32 v32, v32, v40
v_add_f32 v33, v33, v41
v_add_f32 v34, v34, v42
v_add_f32 v35, v35, v43
v_add_f32 v48, v48, v56
v_add_f32 v49, v49, v57
v_add_f32 v50, v50, v58
v_add_f32 v51, v51, v59
v_add_f32 v32, v32, v48
v_add_f32 v33, v33, v49
v_add_f32 v34, v34, v50
v_add_f32 v35, v35, v51
s_waitcnt lgkmcnt(0)
v_add_f32 v64, v64, v68
v_add_f32 v65, v65, v69
v_add_f32 v66, v66, v70
v_add_f32 v67, v67, v71
v_add_f32 v72, v72, v76
v_add_f32 v73, v73, v77
v_add_f32 v74, v74, v78
v_add_f32 v75, v75, v79
v_add_f32 v80, v80, v84
v_add_f32 v81, v81, v85
v_add_f32 v82, v82, v86
v_add_f32 v83, v83, v87
v_add_f32 v88, v88, v92
v_add_f32 v89, v89, v93
v_add_f32 v90, v90, v94
v_add_f32 v91, v91, v95
v_add_f32 v64, v64, v72
v_add_f32 v65, v65, v73
v_add_f32 v66, v66, v74
v_add_f32 v67, v67, v75
v_add_f32 v80, v80, v88
v_add_f32 v81, v81, v89
v_add_f32 v82, v82, v90
v_add_f32 v83, v83, v91
v_add_f32 v64, v64, v80
v_add_f32 v65, v65, v81
v_add_f32 v66, v66, v82
v_add_f32 v67, v67, v83
L_k3_s_20:
ds_write_b128 v12, v[32:35]
ds_write_b128 v12, v[64:67] offset:8192
s_waitcnt vmcnt(0) lgkmcnt(0)
s_barrier
ds_read_b128 v[40:43], v4
ds_read_b128 v[44:47], v5
v_lshlrev_b32 v48, 16, v20
v_and_b32 v49, 0xffff0000, v20
v_lshlrev_b32 v50, 16, v21
v_and_b32 v51, 0xffff0000, v21
v_lshlrev_b32 v52, 16, v22
v_and_b32 v53, 0xffff0000, v22
v_lshlrev_b32 v54, 16, v23
v_and_b32 v55, 0xffff0000, v23
s_waitcnt lgkmcnt(0)
v_add_f32 v40, v40, v48
v_add_f32 v41, v41, v49
v_add_f32 v42, v42, v50
v_add_f32 v43, v43, v51
v_add_f32 v44, v44, v52
v_add_f32 v45, v45, v53
v_add_f32 v46, v46, v54
v_add_f32 v47, v47, v55
v_cvt_pk_bf16_f32 v56, v40, v41
v_cvt_pk_bf16_f32 v57, v42, v43
v_cvt_pk_bf16_f32 v58, v44, v45
v_cvt_pk_bf16_f32 v59, v46, v47
buffer_store_dwordx4 v[56:59], v28, s[16:19], s26 offen sc0 sc1
s_cmp_lt_u32 s20, 2
s_cbranch_scc0 L_k3_c2_21
s_nop 1
ds_read_b128 v[40:43], v6
ds_read_b128 v[44:47], v7
v_lshlrev_b32 v48, 16, v24
v_and_b32 v49, 0xffff0000, v24
v_lshlrev_b32 v50, 16, v25
v_and_b32 v51, 0xffff0000, v25
v_lshlrev_b32 v52, 16, v26
v_and_b32 v53, 0xffff0000, v26
v_lshlrev_b32 v54, 16, v27
v_and_b32 v55, 0xffff0000, v27
s_waitcnt lgkmcnt(0)
v_add_f32 v40, v40, v48
v_add_f32 v41, v41, v49
v_add_f32 v42, v42, v50
v_add_f32 v43, v43, v51
v_add_f32 v44, v44, v52
v_add_f32 v45, v45, v53
v_add_f32 v46, v46, v54
v_add_f32 v47, v47, v55
v_cvt_pk_bf16_f32 v56, v40, v41
v_cvt_pk_bf16_f32 v57, v42, v43
v_cvt_pk_bf16_f32 v58, v44, v45
v_cvt_pk_bf16_f32 v59, v46, v47
buffer_store_dwordx4 v[56:59], v29, s[16:19], s26 offen sc0 sc1
L_k3_c2_21:
L_k3_done:
s_endpgm
L_text_end:
.section .rodata,"a"
.p2align 6
.amdhsa_kernel k1_kernel
  .amdhsa_next_free_vgpr 256
  .amdhsa_next_free_sgpr 100
  .amdhsa_accum_offset 256
  .amdhsa_group_segment_fixed_size 0
  .amdhsa_kernarg_size 88
  .amdhsa_user_sgpr_count 2
  .amdhsa_user_sgpr_kernarg_segment_ptr 1
  .amdhsa_system_sgpr_workgroup_id_x 1
  .amdhsa_float_denorm_mode_32 3
  .amdhsa_float_denorm_mode_16_64 3
.end_amdhsa_kernel
.p2align 6
.amdhsa_kernel k3_kernel
  .amdhsa_next_free_vgpr 256
  .amdhsa_next_free_sgpr 96
  .amdhsa_accum_offset 256
  .amdhsa_group_segment_fixed_size 0
  .amdhsa_kernarg_size 88
  .amdhsa_user_sgpr_count 2
  .amdhsa_user_sgpr_kernarg_segment_ptr 1
  .amdhsa_system_sgpr_workgroup_id_x 1
  .amdhsa_float_denorm_mode_32 3
  .amdhsa_float_denorm_mode_16_64 3
.end_amdhsa_kernel
```
